```python
import torch

def _softmax(x, axis=-1):
    return torch.softmax(x, dim=axis)
def _gelu(x):
    return torch.nn.functional.gelu(x, approximate="tanh")
def _silu(x):
    return torch.nn.functional.silu(x)
def _sigmoid(x):
    return torch.sigmoid(x)
def _layernorm(x, axis=-1, eps=1e-5):
    m = x.mean(dim=axis, keepdim=True)
    v = x.var(dim=axis, keepdim=True, unbiased=False)
    return (x - m) / torch.sqrt(v + eps)
def _scatter_add(tgt, idx, src, axis=0):
    return tgt.clone().index_add_(axis, idx, src)
def _segment_sum(src, seg, n):
    out = torch.zeros((n,) + src.shape[1:], dtype=src.dtype)
    return out.index_add_(0, seg, src)
def _pad(x, pw):
    flat = tuple(v for pair in reversed(pw) for v in pair)
    return torch.nn.functional.pad(x, flat)

kernel_name = 'interleave_layers__ssm_conv_h3__linear_kernel_hedgehog__prompt'

def setup_inputs():

    _w = (lambda a: (lambda t: t.to(torch.bfloat16) if t.is_floating_point() else t)(torch.as_tensor(a)))
    def _A_setup():
        B, S, D = 1, 2048, 576
        ks = 4
        return {
            "q": _w((lambda *s: torch.randn(*s, dtype=torch.bfloat16) * 0.05)(B, S, D)),
            "k": _w((lambda *s: torch.randn(*s, dtype=torch.bfloat16) * 0.8)(B, S, D)),
            "v": _w((lambda *s: torch.randn(*s, dtype=torch.bfloat16) * 0.8)(B, S, D)),
            "shift_k": _w((lambda *s: torch.randn(*s, dtype=torch.bfloat16) * 0.8)(D, ks) * 0.5),
            "ssm_k": _w((lambda *s: torch.randn(*s, dtype=torch.bfloat16) * 0.8)(D, S) * (1.0 / S ** 0.5)),
            "ssm_D": _w((lambda *s: torch.randn(*s, dtype=torch.bfloat16) * 0.8)(D)),
        }
    _A_in = _A_setup()

    def _B_setup():
        B, S, D, H = 1, 2048, 576, 32
        Dh = D // H
        return {
            "x": _w((lambda *s: torch.randn(*s, dtype=torch.bfloat16) * 0.05)(B, S, D)),
            "wqkv": _w((lambda *s: torch.randn(*s, dtype=torch.bfloat16) * 0.4)(D, 3 * D)),
            "w_phi": _w((lambda *s: torch.randn(*s, dtype=torch.bfloat16) * 0.4)(H, Dh, Dh) * (Dh ** -0.5)),
            "wo": _w((lambda *s: torch.randn(*s, dtype=torch.bfloat16) * 0.2)(D, D)),
        }
    _B_in = _B_setup()

    return {
        "A_q": _A_in["q"],
        "A_k": _A_in["k"],
        "A_v": _A_in["v"],
        "A_shift_k": _A_in["shift_k"],
        "A_ssm_k": _A_in["ssm_k"],
        "A_ssm_D": _A_in["ssm_D"],
        "B_x": _B_in["x"],
        "B_wqkv": _B_in["wqkv"],
        "B_w_phi": _B_in["w_phi"],
        "B_wo": _B_in["wo"],
    }

def reference(A_q, A_k, A_v, A_shift_k, A_ssm_k, A_ssm_D, B_x, B_wqkv, B_w_phi, B_wo):
    def _A_ref(q, k, v, shift_k, ssm_k, ssm_D):
        B, S, D = q.shape
        ks = shift_k.shape[-1]
        k_pad = _pad(k, ((0, 0), (ks - 1, 0), (0, 0)))
        k_shift = torch.zeros_like(k)
        for t in range(ks):
            k_shift = k_shift + k_pad[:, t:t + S, :] * shift_k[:, ks - 1 - t][None, None, :]
        kv = k_shift * v
        L = 2 * S
        kv_pad = _pad(kv, ((0, 0), (0, S), (0, 0)))
        kf_pad = _pad(ssm_k, ((0, 0), (0, S)))
        kv_f = (lambda x, axes=(-2,-1): torch.fft.rfft2(x.float(), dim=axes))(kv_pad[:, None, :, :], axes=(1, 2))
        kf_f = (lambda x, axes=(-2,-1): torch.fft.rfft2(x.float(), dim=axes))(kf_pad[:, None, :], axes=(1, 2))
        kf_f = (lambda x, *d: x.permute(*d))(kf_f, 1, 2, 0)
        y_f = kv_f * kf_f[None, :, :, :]
        y = (lambda x, s, axes=(-2,-1): torch.fft.irfft2(x, s=s, dim=axes).to(torch.bfloat16))(y_f, (1, L), axes=(1, 2))[:, 0, :S, :]
        y = y + kv * ssm_D[None, None, :]
        return q * y

    def _B_ref(x, wqkv, w_phi, wo):
        B, S, D = x.shape
        H = 32; Dh = D // H
        qkv = (lambda x, *d: x.permute(*d))((x @ wqkv).reshape(B, S, 3, H, Dh), 2, 0, 3, 1, 4)
        q, k, v = qkv[0], qkv[1], qkv[2]
        pq = torch.einsum("bhsd,hdf->bhsf", q, w_phi)
        pk = torch.einsum("bhsd,hdf->bhsf", k, w_phi)
        phi_q = torch.concatenate([_softmax(pq, axis=-1), _softmax(-pq, axis=-1)], axis=-1)
        phi_k = torch.concatenate([_softmax(pk, axis=-1), _softmax(-pk, axis=-1)], axis=-1)
        kv = torch.einsum("bhsf,bhsd->bhfd", phi_k, v)
        z  = torch.einsum("bhsf->bhf", phi_k)
        num = torch.einsum("bhqf,bhfd->bhqd", phi_q, kv)
        den = torch.einsum("bhqf,bhf->bhq", phi_q, z)[..., None] + 1e-6
        o = num / den
        return (lambda x, *d: x.permute(*d))(o, 0, 2, 1, 3).reshape(B, S, D) @ wo

    x = A_q
    x = x + _A_ref(_layernorm(x, axis=-1), A_k, A_v, A_shift_k, A_ssm_k, A_ssm_D)
    x = x + _B_ref(_layernorm(x, axis=-1), B_wqkv, B_w_phi, B_wo)
    x = x + _A_ref(_layernorm(x, axis=-1), A_k, A_v, A_shift_k, A_ssm_k, A_ssm_D)
    x = x + _B_ref(_layernorm(x, axis=-1), B_wqkv, B_w_phi, B_wo)
    return x
```

```asm
; @launch grid=(256,1,1) block=(256,1,1) lds=163840
.amdgcn_target "amdgcn-amd-amdhsa--gfx950"
.text
.globl interleave_layers__ssm_conv_h3__linear_kernel_hedgehog__prompt_kernel
.p2align 8
.type interleave_layers__ssm_conv_h3__linear_kernel_hedgehog__prompt_kernel,@function
interleave_layers__ssm_conv_h3__linear_kernel_hedgehog__prompt_kernel:
    s_cmp_ge_u32 s2, 256
    s_cbranch_scc1 L_end
    s_load_dwordx16 s[16:31], s[0:1], 0
    s_load_dwordx8 s[32:39], s[0:1], 64
    s_load_dwordx2 s[40:41], s[0:1], 96
    v_lshrrev_b32 v6, 6, v0
    v_and_b32 v1, 63, v0
    v_readfirstlane_b32 s3, v6
    v_and_b32 v2, 15, v0
    v_lshrrev_b32 v3, 4, v1
    v_lshlrev_b32 v4, 4, v1
    s_mov_b32 s46, 16044032
    s_mov_b32 s47, 0x20000
    s_mov_b32 s101, 0xffff0000
    s_and_b32 s5, s2, 7
    s_lshr_b32 s6, s2, 7
    s_lshl_b32 s5, s5, 1
    s_add_u32 s68, s5, s6
    s_bfe_u32 s69, s2, 0x40003
    s_lshr_b32 s5, s69, 3
    s_lshl_b32 s70, s68, 1
    s_add_u32 s70, s70, s5
    s_and_b32 s71, s69, 7
    s_lshl_b32 s72, s68, 2
    s_add_u32 s72, s72, s3
    s_lshr_b32 s5, s3, 1
    s_lshl_b32 s73, s70, 1
    s_add_u32 s73, s73, s5
    s_mov_b32 s66, 2359296
    s_mov_b32 s67, 0x20000
    s_cmp_ge_u32 s2, 208
    s_cbranch_scc1 L_role_w
    s_cmp_ge_u32 s2, 144
    s_cbranch_scc1 L_role_q
    s_mov_b32 s50, 2359296
    s_mov_b32 s51, 0x20000
    s_mov_b32 s54, 2359296
    s_mov_b32 s55, 0x20000
    s_mov_b32 s62, 4608
    s_mov_b32 s63, 0x20000
    s_lshr_b32 s9, s2, 4
    s_and_b32 s10, s2, 15
    s_lshl_b32 s5, s10, 7
    s_lshl_b32 s6, s3, 5
    s_add_u32 s5, s5, s6
    s_mul_i32 s6, s5, 1152
    s_lshl_b32 s7, s9, 7
    s_add_u32 s6, s6, s7
    v_mul_u32_u24 v6, 9216, v3
    v_lshl_add_u32 v6, v2, 3, v6
    v_add_u32 v6, s6, v6
    v_subrev_u32 v7, 3456, v6
    s_lshl_b32 s7, s9, 9
    v_lshlrev_b32 v48, 5, v2
    s_movk_i32 s8, 4608
    s_waitcnt lgkmcnt(0)
    s_mov_b64 s[48:49], s[18:19]
    s_mov_b64 s[52:53], s[20:21]
    s_mov_b64 s[60:61], s[22:23]
    buffer_load_dwordx4 v[50:53], v48, s[60:63], s7 offen
    buffer_load_dwordx4 v[54:57], v48, s[60:63], s7 offen offset:16
    buffer_load_dwordx2 v[8:9], v7, s[48:51], 0 offen offset:0
    buffer_load_dwordx2 v[10:11], v7, s[48:51], 0 offen offset:1152
    buffer_load_dwordx2 v[12:13], v7, s[48:51], 0 offen offset:2304
    buffer_load_dwordx2 v[14:15], v6, s[48:51], 0 offen offset:0
    buffer_load_dwordx2 v[16:17], v6, s[48:51], 0 offen offset:1152
    buffer_load_dwordx2 v[18:19], v6, s[48:51], 0 offen offset:2304
    buffer_load_dwordx2 v[20:21], v6, s[48:51], 0 offen offset:3456
    buffer_load_dwordx2 v[22:23], v6, s[48:51], s8 offen offset:0
    buffer_load_dwordx2 v[24:25], v6, s[48:51], s8 offen offset:1152
    buffer_load_dwordx2 v[26:27], v6, s[48:51], s8 offen offset:2304
    buffer_load_dwordx2 v[28:29], v6, s[48:51], s8 offen offset:3456
    buffer_load_dwordx2 v[30:31], v6, s[52:55], 0 offen offset:0
    buffer_load_dwordx2 v[32:33], v6, s[52:55], 0 offen offset:1152
    buffer_load_dwordx2 v[34:35], v6, s[52:55], 0 offen offset:2304
    buffer_load_dwordx2 v[36:37], v6, s[52:55], 0 offen offset:3456
    buffer_load_dwordx2 v[38:39], v6, s[52:55], s8 offen offset:0
    buffer_load_dwordx2 v[40:41], v6, s[52:55], s8 offen offset:1152
    buffer_load_dwordx2 v[42:43], v6, s[52:55], s8 offen offset:2304
    buffer_load_dwordx2 v[44:45], v6, s[52:55], s8 offen offset:3456
    s_mov_b64 s[44:45], s[40:41]
    s_mov_b64 s[64:65], s[36:37]
    buffer_load_dword v5, off, s[44:47], 0 offset:12 sc1
    s_mov_b64 s[56:57], s[24:25]
    s_mov_b32 s58, 2359296
    s_mov_b32 s59, 0x20000
    s_lshl_b32 s11, s2, 2
    s_add_u32 s11, s11, s3
    s_mul_i32 s12, s3, 13088
    s_add_u32 s12, s12, 111488
    s_lshl_b32 s7, s11, 12
    v_lshlrev_b32 v49, 6, v1
    buffer_load_ushort v46, v49, s[56:59], s7 offen
    s_mov_b64 s[60:61], s[26:27]
    s_mov_b32 s62, 1152
    s_mov_b32 s63, 0x20000
    s_lshl_b32 s7, s11, 1
    buffer_load_ushort v172, off, s[60:63], s7
    s_lshl_b32 s7, s11, 7
    s_add_u32 s7, s7, 4096
    v_mov_b64 v[248:249], 0
    v_mov_b64 v[250:251], 0
    s_mov_b32 exec_lo, 0xff
    s_mov_b32 exec_hi, 0x0
    buffer_store_dwordx4 v[248:251], v4, s[44:47], s7 offen sc1
    s_mov_b64 exec, -1
    s_mul_i32 s7, s9, 262144
    s_lshl_b32 s5, s5, 1
    s_sub_u32 s7, s7, s5
    s_add_u32 s7, s7, 6033392
    v_mul_u32_u24 v7, 16384, v2
    v_lshlrev_b32 v48, 4, v3
    v_sub_u32 v7, v7, v48
    v_add_u32 v7, s7, v7
    s_waitcnt vmcnt(24)
    v_lshlrev_b32 v102, 16, v50
    v_and_b32 v104, s101, v50
    v_lshlrev_b32 v106, 16, v51
    v_and_b32 v108, s101, v51
    v_lshlrev_b32 v103, 16, v52
    v_and_b32 v105, s101, v52
    v_lshlrev_b32 v107, 16, v53
    v_and_b32 v109, s101, v53
    s_waitcnt vmcnt(23)
    v_lshlrev_b32 v110, 16, v54
    v_and_b32 v112, s101, v54
    v_lshlrev_b32 v114, 16, v55
    v_and_b32 v116, s101, v55
    v_lshlrev_b32 v111, 16, v56
    v_and_b32 v113, s101, v56
    v_lshlrev_b32 v115, 16, v57
    v_and_b32 v117, s101, v57
    s_waitcnt vmcnt(22)
    v_lshlrev_b32 v58, 16, v8
    v_and_b32 v59, s101, v8
    v_lshlrev_b32 v60, 16, v9
    v_and_b32 v61, s101, v9
    s_waitcnt vmcnt(21)
    v_lshlrev_b32 v62, 16, v10
    v_and_b32 v63, s101, v10
    v_lshlrev_b32 v64, 16, v11
    v_and_b32 v65, s101, v11
    s_waitcnt vmcnt(20)
    v_lshlrev_b32 v66, 16, v12
    v_and_b32 v67, s101, v12
    v_lshlrev_b32 v68, 16, v13
    v_and_b32 v69, s101, v13
    s_waitcnt vmcnt(19)
    v_lshlrev_b32 v70, 16, v14
    v_and_b32 v71, s101, v14
    v_lshlrev_b32 v72, 16, v15
    v_and_b32 v73, s101, v15
    s_waitcnt vmcnt(18)
    v_lshlrev_b32 v74, 16, v16
    v_and_b32 v75, s101, v16
    v_lshlrev_b32 v76, 16, v17
    v_and_b32 v77, s101, v17
    s_waitcnt vmcnt(17)
    v_lshlrev_b32 v78, 16, v18
    v_and_b32 v79, s101, v18
    v_lshlrev_b32 v80, 16, v19
    v_and_b32 v81, s101, v19
    s_waitcnt vmcnt(16)
    v_lshlrev_b32 v82, 16, v20
    v_and_b32 v83, s101, v20
    v_lshlrev_b32 v84, 16, v21
    v_and_b32 v85, s101, v21
    s_waitcnt vmcnt(15)
    v_lshlrev_b32 v86, 16, v22
    v_and_b32 v87, s101, v22
    v_lshlrev_b32 v88, 16, v23
    v_and_b32 v89, s101, v23
    s_waitcnt vmcnt(14)
    v_lshlrev_b32 v90, 16, v24
    v_and_b32 v91, s101, v24
    v_lshlrev_b32 v92, 16, v25
    v_and_b32 v93, s101, v25
    s_waitcnt vmcnt(13)
    v_lshlrev_b32 v94, 16, v26
    v_and_b32 v95, s101, v26
    v_lshlrev_b32 v96, 16, v27
    v_and_b32 v97, s101, v27
    s_waitcnt vmcnt(12)
    v_lshlrev_b32 v98, 16, v28
    v_and_b32 v99, s101, v28
    v_lshlrev_b32 v100, 16, v29
    v_and_b32 v101, s101, v29
    s_waitcnt vmcnt(11)
    v_lshlrev_b32 v118, 16, v30
    v_and_b32 v119, s101, v30
    v_lshlrev_b32 v120, 16, v31
    v_and_b32 v121, s101, v31
    v_pk_mul_f32 v[150:151], v[70:71], v[102:103]
    v_pk_mul_f32 v[152:153], v[72:73], v[110:111]
    v_pk_fma_f32 v[150:151], v[66:67], v[104:105], v[150:151]
    v_pk_fma_f32 v[152:153], v[68:69], v[112:113], v[152:153]
    v_pk_fma_f32 v[150:151], v[62:63], v[106:107], v[150:151]
    v_pk_fma_f32 v[152:153], v[64:65], v[114:115], v[152:153]
    v_pk_fma_f32 v[150:151], v[58:59], v[108:109], v[150:151]
    v_pk_fma_f32 v[152:153], v[60:61], v[116:117], v[152:153]
    v_pk_mul_f32 v[118:119], v[118:119], v[150:151]
    v_pk_mul_f32 v[120:121], v[120:121], v[152:153]
    s_waitcnt vmcnt(10)
    v_lshlrev_b32 v122, 16, v32
    v_and_b32 v123, s101, v32
    v_lshlrev_b32 v124, 16, v33
    v_and_b32 v125, s101, v33
    v_pk_mul_f32 v[150:151], v[74:75], v[102:103]
    v_pk_mul_f32 v[152:153], v[76:77], v[110:111]
    v_pk_fma_f32 v[150:151], v[70:71], v[104:105], v[150:151]
    v_pk_fma_f32 v[152:153], v[72:73], v[112:113], v[152:153]
    v_pk_fma_f32 v[150:151], v[66:67], v[106:107], v[150:151]
    v_pk_fma_f32 v[152:153], v[68:69], v[114:115], v[152:153]
    v_pk_fma_f32 v[150:151], v[62:63], v[108:109], v[150:151]
    v_pk_fma_f32 v[152:153], v[64:65], v[116:117], v[152:153]
    v_pk_mul_f32 v[122:123], v[122:123], v[150:151]
    v_pk_mul_f32 v[124:125], v[124:125], v[152:153]
    s_waitcnt vmcnt(9)
    v_lshlrev_b32 v126, 16, v34
    v_and_b32 v127, s101, v34
    v_lshlrev_b32 v128, 16, v35
    v_and_b32 v129, s101, v35
    v_pk_mul_f32 v[150:151], v[78:79], v[102:103]
    v_pk_mul_f32 v[152:153], v[80:81], v[110:111]
    v_pk_fma_f32 v[150:151], v[74:75], v[104:105], v[150:151]
    v_pk_fma_f32 v[152:153], v[76:77], v[112:113], v[152:153]
    v_pk_fma_f32 v[150:151], v[70:71], v[106:107], v[150:151]
    v_pk_fma_f32 v[152:153], v[72:73], v[114:115], v[152:153]
    v_pk_fma_f32 v[150:151], v[66:67], v[108:109], v[150:151]
    v_pk_fma_f32 v[152:153], v[68:69], v[116:117], v[152:153]
    v_pk_mul_f32 v[126:127], v[126:127], v[150:151]
    v_pk_mul_f32 v[128:129], v[128:129], v[152:153]
    s_waitcnt vmcnt(8)
    v_lshlrev_b32 v130, 16, v36
    v_and_b32 v131, s101, v36
    v_lshlrev_b32 v132, 16, v37
    v_and_b32 v133, s101, v37
    v_pk_mul_f32 v[150:151], v[82:83], v[102:103]
    v_pk_mul_f32 v[152:153], v[84:85], v[110:111]
    v_pk_fma_f32 v[150:151], v[78:79], v[104:105], v[150:151]
    v_pk_fma_f32 v[152:153], v[80:81], v[112:113], v[152:153]
    v_pk_fma_f32 v[150:151], v[74:75], v[106:107], v[150:151]
    v_pk_fma_f32 v[152:153], v[76:77], v[114:115], v[152:153]
    v_pk_fma_f32 v[150:151], v[70:71], v[108:109], v[150:151]
    v_pk_fma_f32 v[152:153], v[72:73], v[116:117], v[152:153]
    v_pk_mul_f32 v[130:131], v[130:131], v[150:151]
    v_pk_mul_f32 v[132:133], v[132:133], v[152:153]
    s_waitcnt vmcnt(7)
    v_lshlrev_b32 v134, 16, v38
    v_and_b32 v135, s101, v38
    v_lshlrev_b32 v136, 16, v39
    v_and_b32 v137, s101, v39
    v_pk_mul_f32 v[150:151], v[86:87], v[102:103]
    v_pk_mul_f32 v[152:153], v[88:89], v[110:111]
    v_pk_fma_f32 v[150:151], v[82:83], v[104:105], v[150:151]
    v_pk_fma_f32 v[152:153], v[84:85], v[112:113], v[152:153]
    v_pk_fma_f32 v[150:151], v[78:79], v[106:107], v[150:151]
    v_pk_fma_f32 v[152:153], v[80:81], v[114:115], v[152:153]
    v_pk_fma_f32 v[150:151], v[74:75], v[108:109], v[150:151]
    v_pk_fma_f32 v[152:153], v[76:77], v[116:117], v[152:153]
    v_pk_mul_f32 v[134:135], v[134:135], v[150:151]
    v_pk_mul_f32 v[136:137], v[136:137], v[152:153]
    s_waitcnt vmcnt(6)
    v_lshlrev_b32 v138, 16, v40
    v_and_b32 v139, s101, v40
    v_lshlrev_b32 v140, 16, v41
    v_and_b32 v141, s101, v41
    v_pk_mul_f32 v[150:151], v[90:91], v[102:103]
    v_pk_mul_f32 v[152:153], v[92:93], v[110:111]
    v_pk_fma_f32 v[150:151], v[86:87], v[104:105], v[150:151]
    v_pk_fma_f32 v[152:153], v[88:89], v[112:113], v[152:153]
    v_pk_fma_f32 v[150:151], v[82:83], v[106:107], v[150:151]
    v_pk_fma_f32 v[152:153], v[84:85], v[114:115], v[152:153]
    v_pk_fma_f32 v[150:151], v[78:79], v[108:109], v[150:151]
    v_pk_fma_f32 v[152:153], v[80:81], v[116:117], v[152:153]
    v_pk_mul_f32 v[138:139], v[138:139], v[150:151]
    v_pk_mul_f32 v[140:141], v[140:141], v[152:153]
    s_waitcnt vmcnt(5)
    v_lshlrev_b32 v142, 16, v42
    v_and_b32 v143, s101, v42
    v_lshlrev_b32 v144, 16, v43
    v_and_b32 v145, s101, v43
    v_pk_mul_f32 v[150:151], v[94:95], v[102:103]
    v_pk_mul_f32 v[152:153], v[96:97], v[110:111]
    v_pk_fma_f32 v[150:151], v[90:91], v[104:105], v[150:151]
    v_pk_fma_f32 v[152:153], v[92:93], v[112:113], v[152:153]
    v_pk_fma_f32 v[150:151], v[86:87], v[106:107], v[150:151]
    v_pk_fma_f32 v[152:153], v[88:89], v[114:115], v[152:153]
    v_pk_fma_f32 v[150:151], v[82:83], v[108:109], v[150:151]
    v_pk_fma_f32 v[152:153], v[84:85], v[116:117], v[152:153]
    v_pk_mul_f32 v[142:143], v[142:143], v[150:151]
    v_pk_mul_f32 v[144:145], v[144:145], v[152:153]
    s_waitcnt vmcnt(4)
    v_lshlrev_b32 v146, 16, v44
    v_and_b32 v147, s101, v44
    v_lshlrev_b32 v148, 16, v45
    v_and_b32 v149, s101, v45
    v_pk_mul_f32 v[150:151], v[98:99], v[102:103]
    v_pk_mul_f32 v[152:153], v[100:101], v[110:111]
    v_pk_fma_f32 v[150:151], v[94:95], v[104:105], v[150:151]
    v_pk_fma_f32 v[152:153], v[96:97], v[112:113], v[152:153]
    v_pk_fma_f32 v[150:151], v[90:91], v[106:107], v[150:151]
    v_pk_fma_f32 v[152:153], v[92:93], v[114:115], v[152:153]
    v_pk_fma_f32 v[150:151], v[86:87], v[108:109], v[150:151]
    v_pk_fma_f32 v[152:153], v[88:89], v[116:117], v[152:153]
    v_pk_mul_f32 v[146:147], v[146:147], v[150:151]
    v_pk_mul_f32 v[148:149], v[148:149], v[152:153]
    v_cvt_pk_bf16_f32 v156, v146, v142
    v_cvt_pk_bf16_f32 v157, v138, v134
    v_cvt_pk_bf16_f32 v158, v130, v126
    v_cvt_pk_bf16_f32 v159, v122, v118
    s_movk_i32 s7, 0
    buffer_store_dwordx4 v[156:159], v7, s[44:47], s7 offen sc1
    v_cvt_pk_bf16_f32 v160, v147, v143
    v_cvt_pk_bf16_f32 v161, v139, v135
    v_cvt_pk_bf16_f32 v162, v131, v127
    v_cvt_pk_bf16_f32 v163, v123, v119
    s_movk_i32 s7, 4096
    buffer_store_dwordx4 v[160:163], v7, s[44:47], s7 offen sc1
    v_cvt_pk_bf16_f32 v164, v148, v144
    v_cvt_pk_bf16_f32 v165, v140, v136
    v_cvt_pk_bf16_f32 v166, v132, v128
    v_cvt_pk_bf16_f32 v167, v124, v120
    s_movk_i32 s7, 8192
    buffer_store_dwordx4 v[164:167], v7, s[44:47], s7 offen sc1
    v_cvt_pk_bf16_f32 v168, v149, v145
    v_cvt_pk_bf16_f32 v169, v141, v137
    v_cvt_pk_bf16_f32 v170, v133, v129
    v_cvt_pk_bf16_f32 v171, v125, v121
    s_movk_i32 s7, 12288
    buffer_store_dwordx4 v[168:171], v7, s[44:47], s7 offen sc1
    s_waitcnt vmcnt(7)
    v_readfirstlane_b32 s4, v5
    s_nop 0
    s_mul_i32 s4, s4, 0x9e3779b1
    s_add_u32 s4, s4, 0x7f4a7c15
    s_or_b32 s4, s4, 1
    v_mov_b32 v5, s4
    s_getreg_b32 s100, hwreg(HW_REG_XCC_ID, 0, 4)
    s_cmp_lg_u32 s3, 0
    s_cbranch_scc1 L_skip_1
    s_lshl_b32 s5, s68, 4
    s_add_u32 s5, s5, s69
    s_lshl_b32 s5, s5, 7
    s_add_u32 s5, s5, 102400
    v_mov_b32 v186, s100
    v_mov_b32 v187, v5
    s_mov_b32 exec_lo, 0xff
    s_mov_b32 exec_hi, 0x0
    buffer_store_dwordx4 v[184:187], v4, s[44:47], s5 offen sc1
    s_mov_b64 exec, -1
    s_nop 0
L_skip_1:
    s_lshl_b32 s8, s11, 7
    s_add_u32 s8, s8, 4096
    v_add_u32 v49, 2, v4
    s_waitcnt vmcnt(6)
    v_readfirstlane_b32 s6, v46
    s_waitcnt vmcnt(0)
    s_mov_b32 exec_lo, 0xff
    s_mov_b32 exec_hi, 0x0
    buffer_store_dwordx4 v[2:5], v4, s[44:47], s8 offen sc1
    s_mov_b64 exec, -1
    s_lshl_b32 s7, s11, 12
    s_add_u32 s5, s12, 4640
    s_mov_b32 m0, s5
    s_nop 0
    buffer_load_dwordx4 v4, s[56:59], s7 offen lds
    buffer_load_dwordx4 v4, s[56:59], s7 offen offset:1024 lds
    buffer_load_dwordx4 v4, s[56:59], s7 offen offset:2048 lds
    buffer_load_dwordx4 v4, s[56:59], s7 offen offset:3072 lds
    s_add_u32 s5, s12, 8800
    s_mov_b32 m0, s5
    s_nop 0
    buffer_load_dwordx4 v49, s[56:59], s7 offen lds
    buffer_load_dwordx4 v49, s[56:59], s7 offen offset:1024 lds
    buffer_load_dwordx4 v49, s[56:59], s7 offen offset:2048 lds
    buffer_load_dwordx4 v49, s[56:59], s7 offen offset:3072 lds
    v_mov_b32 v46, s6
    v_mov_b64 v[176:177], 0
    v_mov_b64 v[178:179], 0
    s_mul_i32 s8, s3, 144
    s_add_u32 s8, s8, s2
    s_lshl_b32 s8, s8, 7
    s_add_u32 s8, s8, 147456
    s_mov_b32 exec_lo, 0xff
    s_mov_b32 exec_hi, 0x0
    buffer_store_dwordx4 v[176:179], v4, s[44:47], s8 offen sc1
    s_mov_b64 exec, -1
    s_lshr_b32 s5, s68, 2
    s_mul_i32 s5, s5, 144
    s_mul_i32 s6, s3, 36
    s_add_u32 s5, s5, s6
    s_lshl_b32 s5, s5, 7
    s_add_u32 s5, s5, 147456
    s_lshr_b32 s6, s71, 1
    s_lshl_b32 s6, s6, 11
    s_lshl_b32 s7, s3, 9
    s_add_u32 s6, s6, s7
    s_add_u32 s6, s6, 89600
    v_mov_b32 v196, s5
    v_mov_b32 v197, s6
    v_cmp_gt_u32 vcc, 36, v1
    s_nop 1
    v_cndmask_b32 v196, v197, v196, vcc
    v_lshl_add_u32 v196, v1, 7, v196
    v_accvgpr_write_b32 a224, v196
    v_and_b32 v193, 7, v2
    v_lshrrev_b32 v194, 3, v2
    s_and_b32 s8, s3, 1
    v_lshlrev_b32 v192, 7, v3
    v_lshl_add_u32 v192, v193, 4, v192
    v_mul_u32_u24 v195, 18432, v194
    v_add_u32 v195, v195, v192
    v_accvgpr_write_b32 a225, v195
    s_mov_b32 s43, 0
    s_mul_i32 s86, s72, 36864
    s_add_u32 s86, s86, 11059200
    v_and_b32 v188, 3, v1
    v_bfe_u32 v189, v1, 2, 2
    s_mul_i32 s5, s3, 8448
    s_add_u32 s5, s5, 129024
    v_mul_u32_u24 v186, 264, v2
    v_mad_u32_u24 v186, v3, 40, v186
    v_add_u32 v186, s5, v186
    v_accvgpr_write_b32 a200, v186
    v_and_b32 v186, 1, v3
    v_lshlrev_b32 v186, 4, v186
    v_lshl_add_u32 v186, v189, 2, v186
    v_and_b32 v187, 2, v3
    v_add_u32 v186, v186, v187
    v_mul_u32_u24 v190, 264, v186
    v_add_u32 v190, 129024, v190
    s_lshr_b32 s7, s3, 1
    s_mul_i32 s5, s7, 80
    v_lshrrev_b32 v186, 1, v188
    v_mad_u32_u24 v191, v186, 40, v190
    v_add_u32 v191, s5, v191
    v_and_b32 v186, 1, v188
    v_mad_u32_u24 v187, v186, 24, v191
    v_add_u32 v187, 0, v187
    v_accvgpr_write_b32 a201, v187
    v_mad_u32_u24 v187, v186, 24, v191
    v_add_u32 v187, 8, v187
    v_accvgpr_write_b32 a202, v187
    v_mad_u32_u24 v187, v186, 16, v191
    v_add_u32 v187, 16, v187
    v_accvgpr_write_b32 a203, v187
    s_mul_i32 s5, s3, 24
    s_add_u32 s5, s5, 160
    v_min_u32 v186, 2, v188
    v_lshl_add_u32 v186, v186, 3, v190
    v_add_u32 v186, s5, v186
    v_accvgpr_write_b32 a204, v186
    s_mul_i32 s5, s3, 960
    v_lshlrev_b32 v186, 6, v2
    v_lshl_add_u32 v186, v3, 4, v186
    v_add_u32 v186, s5, v186
    v_accvgpr_write_b32 a205, v186
    v_lshrrev_b32 v186, 1, v3
    v_lshl_add_u32 v186, v2, 1, v186
    v_lshlrev_b32 v186, 4, v186
    s_add_u32 s5, s5, 640
    v_add_u32 v186, s5, v186
    v_accvgpr_write_b32 a220, v186
    s_mul_i32 s5, s68, 15
    v_lshrrev_b32 v186, 4, v0
    v_min_u32 v187, 14, v186
    v_add_u32 v187, s5, v187
    v_lshlrev_b32 v187, 4, v187
    v_lshl_add_u32 v187, v2, 12, v187
    v_accvgpr_write_b32 a206, v187
    v_and_b32 v193, 7, v2
    v_lshrrev_b32 v194, 3, v2
    s_and_b32 s8, s3, 1
    s_mul_i32 s5, s73, 36864
    s_mul_i32 s6, s8, 18432
    s_add_u32 s5, s5, s6
    s_mul_i32 s6, s71, 2304
    s_add_u32 s5, s5, s6
    v_lshlrev_b32 v192, 7, v3
    v_lshl_add_u32 v192, v193, 4, v192
    v_add_u32 v192, s5, v192
    v_lshl_add_u32 v195, v194, 3, v192
    v_accvgpr_write_b32 a226, v195
    v_lshl_add_u32 v195, v194, 9, v192
    v_accvgpr_write_b32 a217, v195
    v_and_b32 v196, 3, v2
    v_lshlrev_b32 v195, 8, v3
    v_lshl_add_u32 v195, v196, 6, v195
    v_lshrrev_b32 v196, 2, v2
    v_lshl_add_u32 v195, v196, 4, v195
    v_accvgpr_write_b32 a222, v195
    s_lshl_b32 s5, s72, 10
    s_add_u32 s5, s5, 946176
    v_lshlrev_b32 v195, 9, v194
    v_lshl_add_u32 v195, v3, 6, v195
    v_lshl_add_u32 v195, v193, 2, v195
    v_add_u32 v195, s5, v195
    v_accvgpr_write_b32 a228, v195
    s_mov_b32 s87, 11059200
    s_lshl_b32 s15, s68, 11
    s_add_u32 s15, s15, 225280
    s_mov_b32 s80, 0x00100001
    s_mov_b32 s81, 0x10000100
    s_lshl_b32 s88, s69, 16
    s_add_u32 s88, s88, 1142784
    s_lshl_b32 s89, s69, 12
    s_add_u32 s89, s89, 1011712
    s_mov_b32 s90, 290816
    v_lshrrev_b32 v186, 4, v0
    s_lshl_b32 s5, s68, 8
    v_lshl_add_u32 v186, v186, 4, s5
    v_accvgpr_write_b32 a207, v186
    v_mul_u32_u24 v186, 4370, v0
    v_lshrrev_b32 v186, 16, v186
    v_add_lshl_u32 v186, v186, v0, 4
    v_accvgpr_write_b32 a221, v186
    s_movk_i32 s7, 240
    v_cmp_gt_u32 s[76:77], s7, v0
    v_mul_u32_u24 v192, 1093, v0
    v_lshrrev_b32 v192, 16, v192
    v_mul_u32_u24 v193, 60, v192
    v_sub_u32 v193, v0, v193
    v_cmp_le_u32 vcc, 40, v193
    v_lshrrev_b32 v194, 2, v193
    v_subrev_u32 v195, 40, v193
    v_lshrrev_b32 v195, 1, v195
    v_cndmask_b32 v194, v194, v195, vcc
    v_and_b32 v195, 3, v193
    v_mul_u32_u24 v195, 24, v195
    v_and_b32 v196, 1, v193
    v_mad_u32_u24 v196, v196, 48, 12
    v_cndmask_b32 v195, v195, v196, vcc
    v_and_b32 v196, 1, v192
    v_mad_u32_u24 v196, v196, 9, v194
    v_cmp_ne_u32 vcc, 18, v196
    s_nop 0
    s_and_b64 s[78:79], s[76:77], vcc
    v_cmp_eq_u32 vcc, 9, v194
    v_mov_b32 v197, 18
    s_nop 0
    v_cndmask_b32 v196, v196, v197, vcc
    v_lshrrev_b32 v192, 1, v192
    v_mad_u32_u24 v196, v192, 19, v196
    v_mul_u32_u24 v196, 96, v196
    v_add_u32 v196, v196, v195
    v_add_u32 v196, 86016, v196
    v_accvgpr_write_b32 a208, v196
    v_add_u32 v196, 12, v196
    v_mul_u32_u24 v197, 12, v0
    v_add_u32 v197, 86784, v197
    v_cndmask_b32 v196, v197, v196, s[76:77]
    v_accvgpr_write_b32 a223, v196
    v_cmp_gt_u32 vcc, 40, v193
    s_nop 0
    s_and_b64 s[74:75], s[78:79], vcc
    s_mov_b32 vcc_lo, 0xaaaaaaaa
    s_mov_b32 vcc_hi, 0xaaaaaaaa
    s_and_b64 s[74:75], s[74:75], vcc
    s_orn2_b64 s[74:75], s[74:75], s[76:77]
    v_lshrrev_b32 v192, 3, v2
    v_lshrrev_b32 v193, 1, v3
    v_cmp_eq_u32 vcc, v192, v193
    v_mul_u32_u24 v192, 1824, v192
    v_and_b32 v193, 1, v3
    v_mad_u32_u24 v192, v193, 48, v192
    v_add_u32 v192, 86016, v192
    v_bfe_u32 v193, v2, 2, 1
    v_and_b32 v194, 3, v2
    v_lshl_add_u32 v193, v193, 3, v194
    v_mov_b32 v197, 89664
    s_movk_i32 s5, 96
    v_add_u32 v195, 0, v193
    v_mad_u32_u24 v195, v195, s5, v192
    v_cndmask_b32 v195, v197, v195, vcc
    v_accvgpr_write_b32 a209, v195
    v_add_u32 v195, 4, v193
    v_mad_u32_u24 v195, v195, s5, v192
    v_cndmask_b32 v195, v197, v195, vcc
    v_accvgpr_write_b32 a210, v195
    v_lshlrev_b32 v195, 3, v194
    v_mov_b32 v198, 0x12111012
    v_lshrrev_b32 v195, v195, v198
    v_and_b32 v195, 0xff, v195
    v_mad_u32_u24 v195, v195, s5, v192
    v_cndmask_b32 v195, v197, v195, vcc
    v_accvgpr_write_b32 a211, v195
    s_mul_i32 s5, s72, 36864
    v_lshrrev_b32 v192, 3, v2
    v_mul_u32_u24 v192, 18432, v192
    v_and_b32 v193, 7, v2
    v_lshl_add_u32 v192, v193, 4, v192
    v_add_u32 v192, s5, v192
    s_lshl_b32 s5, s69, 10
    v_lshl_add_u32 v194, v3, 8, v192
    v_add_u32 v194, s5, v194
    v_accvgpr_write_b32 a212, v194
    s_lshl_b32 s5, s69, 7
    s_add_u32 s5, s5, 16384
    v_lshlrev_b32 v194, 3, v193
    v_sub_u32 v194, v192, v194
    v_lshrrev_b32 v195, 1, v3
    v_lshl_add_u32 v194, v195, 6, v194
    v_add_u32 v194, s5, v194
    v_accvgpr_write_b32 a213, v194
    v_and_b32 v193, 7, v2
    s_and_b32 s8, s3, 1
    s_mul_i32 s5, s73, 36864
    s_mul_i32 s6, s71, 4608
    s_add_u32 s5, s5, s6
    s_lshl_b32 s6, s8, 7
    s_add_u32 s5, s5, s6
    v_lshlrev_b32 v192, 8, v3
    v_lshl_add_u32 v192, v193, 4, v192
    v_add_u32 v192, s5, v192
    v_lshrrev_b32 v194, 3, v2
    v_lshl_add_u32 v195, v194, 3, v192
    v_accvgpr_write_b32 a214, v195
    s_lshl_b32 s5, s70, 13
    s_lshl_b32 s6, s3, 8
    s_add_u32 s5, s5, s6
    s_add_u32 s5, s5, 684032
    v_lshl_add_u32 v195, v2, 4, s5
    v_lshl_add_u32 v196, v3, 10, v195
    v_accvgpr_write_b32 a216, v196
    s_lshl_b32 s6, s71, 10
    v_add_u32 v195, s6, v195
    v_accvgpr_write_b32 a215, v195
    s_lshl_b32 s5, s73, 5
    s_lshl_b32 s6, s8, 3
    s_add_u32 s5, s5, s6
    s_mul_i32 s5, s5, 1152
    s_mul_i32 s6, s71, 144
    s_add_u32 s5, s5, s6
    v_lshl_add_u32 v195, v194, 4, v193
    v_mul_u32_u24 v195, 1152, v195
    v_and_b32 v196, 1, v3
    v_lshl_add_u32 v195, v196, 5, v195
    v_lshrrev_b32 v196, 1, v3
    v_lshl_add_u32 v195, v196, 4, v195
    v_add_u32 v195, s5, v195
    v_accvgpr_write_b32 a218, v195
    v_lshlrev_b32 v195, 7, v3
    v_lshl_add_u32 v195, v193, 4, v195
    v_add_u32 v195, 4096, v195
    v_accvgpr_write_b32 a219, v195
    s_lshl_b32 s5, s72, 4
    s_add_u32 s5, s5, s69
    s_lshl_b32 s5, s5, 7
    s_add_u32 s5, s5, 290816
    v_accvgpr_read_b32 v195, a215
    v_writelane_b32 v195, s5, 1
    s_add_u32 s5, s5, 131072
    v_writelane_b32 v195, s5, 2
    s_lshl_b32 s5, s73, 4
    s_lshl_b32 s6, s71, 1
    s_add_u32 s5, s5, s6
    s_and_b32 s6, s3, 1
    s_add_u32 s5, s5, s6
    s_lshl_b32 s5, s5, 7
    s_add_u32 s5, s5, 552960
    v_writelane_b32 v195, s5, 3
    s_lshl_b32 s5, s69, 7
    s_add_u32 s5, s5, s15
    v_writelane_b32 v195, s5, 4
    s_add_u32 s5, s5, 32768
    v_writelane_b32 v195, s5, 5
    s_lshl_b32 s5, s70, 2
    s_add_u32 s5, s5, s3
    s_lshl_b32 s5, s5, 3
    s_add_u32 s5, s5, s71
    s_lshl_b32 s5, s5, 6
    s_add_u32 s5, s5, 946176
    v_writelane_b32 v195, s5, 6
    v_accvgpr_write_b32 a227, v195
    v_lshl_add_u32 v195, v2, 2, s5
    v_accvgpr_write_b32 a229, v195
    v_mov_b64 v[180:181], 0
    v_mov_b64 v[182:183], 0
    s_lshl_b32 s5, s72, 4
    s_add_u32 s5, s5, s69
    s_lshl_b32 s5, s5, 7
    s_add_u32 s5, s5, 290816
    s_add_u32 s6, s5, 131072
    s_lshl_b32 s7, s73, 4
    s_lshl_b32 s8, s71, 1
    s_add_u32 s7, s7, s8
    s_and_b32 s8, s3, 1
    s_add_u32 s7, s7, s8
    s_lshl_b32 s7, s7, 7
    s_add_u32 s7, s7, 552960
    s_mov_b32 exec_lo, 0xff
    s_mov_b32 exec_hi, 0x0
    buffer_store_dwordx4 v[180:183], v4, s[44:47], s5 offen sc1
    buffer_store_dwordx4 v[180:183], v4, s[44:47], s6 offen sc1
    buffer_store_dwordx4 v[180:183], v4, s[44:47], s7 offen sc1
    s_lshl_b32 s5, s69, 7
    s_add_u32 s5, s5, s15
    s_add_u32 s6, s5, 32768
    s_cmp_lg_u32 s3, 0
    s_cbranch_scc1 L_skip_2
    buffer_store_dwordx4 v[180:183], v4, s[44:47], s5 offen sc1
    buffer_store_dwordx4 v[180:183], v4, s[44:47], s6 offen sc1
    s_nop 1
L_skip_2:
    s_mov_b64 exec, -1
    v_accvgpr_read_b32 v184, a215
    v_accvgpr_read_b32 v185, a207
    s_lshl_b32 s5, s68, 12
    s_mul_i32 s6, s3, 960
    s_add_u32 s5, s5, s6
    s_add_u32 s5, s5, s88
    s_add_u32 s6, s5, 1048576
    s_add_u32 s7, s89, 65536
    s_mov_b32 exec_lo, 0xffffffff
    s_mov_b32 exec_hi, 0xfffffff
    buffer_store_dwordx4 v[180:183], v4, s[44:47], s5 offen sc1
    buffer_store_dwordx4 v[180:183], v4, s[44:47], s6 offen sc1
    s_mov_b32 exec_lo, 0x10001
    s_mov_b32 exec_hi, 0x10001
    buffer_store_dwordx4 v[180:183], v185, s[44:47], s89 offen sc1
    buffer_store_dwordx4 v[180:183], v185, s[44:47], s7 offen sc1
    s_mov_b32 exec_lo, 0xffff
    s_mov_b32 exec_hi, 0x0
    buffer_store_dwordx4 v[180:183], v184, s[44:47], 0 offen sc1
    v_accvgpr_read_b32 v184, a229
    buffer_store_dword v180, v184, s[44:47], 0 offen sc1
    s_mov_b64 exec, -1
    v_mov_b64 v[8:9], 0
    v_lshl_add_u32 v6, v1, 3, s12
    ds_write_b64 v6, v[8:9] offset:4096
    v_and_b32 v6, 7, v1
    v_lshrrev_b32 v7, 3, v1
    v_mul_u32_u24 v7, 4160, v7
    v_lshl_add_u32 v6, v6, 2, v7
    v_add_u32 v6, s12, v6
    v_lshlrev_b32 v46, 16, v46
    v_cmp_eq_u32 vcc, 15, v1
    s_nop 1
    v_cndmask_b32 v46, 0, v46, vcc
    s_mov_b32 exec_lo, 0xffff
    s_mov_b32 exec_hi, 0x0
    ds_write_b32 v6, v46 offset:4608
    s_mov_b64 exec, -1
    v_lshlrev_b32 v6, 5, v2
    v_lshlrev_b32 v7, 4, v3
    v_sub_u32 v10, v7, v6
    s_add_u32 s7, s12, 480
    v_add_u32 v10, s7, v10
    v_and_b32 v6, 1, v2
    v_cmp_eq_u32 vcc, 1, v6
    v_mov_b32 v13, 4160
    v_mov_b32 v14, 2
    v_cndmask_b32 v12, v13, v14, vcc
    v_lshl_add_u32 v12, v2, 1, v12
    v_add_u32 v12, v7, v12
    s_add_u32 s7, s12, 4608
    v_add_u32 v12, s7, v12
    v_add_u32 v13, 1024, v12
    v_add_u32 v14, 2048, v12
    v_add_u32 v15, 3072, v12
    v_lshlrev_b32 v6, 3, v3
    v_add_u32 v6, v6, v2
    v_sub_u32 v6, 15, v6
    v_lshlrev_b32 v7, 16, v172
    v_cmp_eq_u32 vcc, 0, v6
    s_nop 1
    v_cndmask_b32 v16, 0, v172, vcc
    v_cmp_eq_u32 vcc, 1, v6
    s_nop 1
    v_cndmask_b32 v16, v16, v7, vcc
    v_cmp_eq_u32 vcc, 2, v6
    s_nop 1
    v_cndmask_b32 v17, 0, v172, vcc
    v_cmp_eq_u32 vcc, 3, v6
    s_nop 1
    v_cndmask_b32 v17, v17, v7, vcc
    v_cmp_eq_u32 vcc, 4, v6
    s_nop 1
    v_cndmask_b32 v18, 0, v172, vcc
    v_cmp_eq_u32 vcc, 5, v6
    s_nop 1
    v_cndmask_b32 v18, v18, v7, vcc
    v_cmp_eq_u32 vcc, 6, v6
    s_nop 1
    v_cndmask_b32 v19, 0, v172, vcc
    v_cmp_eq_u32 vcc, 7, v6
    s_nop 1
    v_cndmask_b32 v19, v19, v7, vcc
    v_lshlrev_b32 v21, 7, v1
    s_lshl_b32 s7, s9, 13
    s_add_u32 s7, s7, 4096
    s_waitcnt vmcnt(18)
    s_mov_b64 exec, -1
    s_mov_b32 s42, 400000
L_poll_3:
    buffer_load_dword v20, v21, s[44:47], s7 offen offset:12 sc1
    s_waitcnt vmcnt(0)
    v_cmp_ne_u32 vcc, s4, v20
    s_nop 1
    s_cbranch_vccz L_polld_4
    s_mov_b64 exec, vcc
    s_sub_u32 s42, s42, 1
    s_cbranch_scc0 L_poll_3
L_polld_4:
    s_mov_b64 exec, -1
    s_mul_i32 s7, s11, 4096
    s_add_u32 s7, s7, 6029312
    s_mov_b32 s8, s12
    s_mov_b32 m0, s8
    s_nop 0
    buffer_load_dwordx4 v4, s[44:47], s7 offen sc1 lds
    buffer_load_dwordx4 v4, s[44:47], s7 offen offset:1024 sc1 lds
    buffer_load_dwordx4 v4, s[44:47], s7 offen offset:2048 sc1 lds
    buffer_load_dwordx4 v4, s[44:47], s7 offen offset:3072 sc1 lds
    ds_read2_b32 a[0:1], v12 offset0:0 offset1:1
    ds_read2_b32 a[2:3], v12 offset0:2 offset1:3
    ds_read2_b32 a[4:5], v12 offset0:128 offset1:129
    ds_read2_b32 a[6:7], v12 offset0:130 offset1:131
    ds_read2_b32 a[8:9], v13 offset0:0 offset1:1
    ds_read2_b32 a[10:11], v13 offset0:2 offset1:3
    ds_read2_b32 a[12:13], v13 offset0:128 offset1:129
    ds_read2_b32 a[14:15], v13 offset0:130 offset1:131
    ds_read2_b32 a[16:17], v14 offset0:0 offset1:1
    ds_read2_b32 a[18:19], v14 offset0:2 offset1:3
    ds_read2_b32 a[20:21], v14 offset0:128 offset1:129
    ds_read2_b32 a[22:23], v14 offset0:130 offset1:131
    ds_read2_b32 a[24:25], v15 offset0:0 offset1:1
    ds_read2_b32 a[26:27], v15 offset0:2 offset1:3
    ds_read2_b32 a[28:29], v15 offset0:128 offset1:129
    ds_read2_b32 a[30:31], v15 offset0:130 offset1:131
    s_mul_i32 s7, s3, 589824
    s_lshl_b32 s8, s2, 8
    s_add_u32 s7, s7, s8
    v_mul_u32_u24 v22, 73728, v3
    v_lshl_add_u32 v22, v2, 4, v22
    v_add_u32 v22, s7, v22
    s_mul_i32 s7, s3, 589824
    s_lshl_b32 s8, s2, 7
    s_add_u32 s7, s7, s8
    v_lshrrev_b32 v6, 3, v2
    v_mul_u32_u24 v28, 18304, v6
    v_lshl_add_u32 v28, v2, 4, v28
    v_mul_u32_u24 v6, 73728, v3
    v_add3_u32 v28, v28, v6, s7
    v_lshlrev_b32 v23, 5, v2
    v_lshl_add_u32 v23, v3, 3, v23
    v_add_u32 v23, s12, v23
    v_bfe_u32 v6, v1, 2, 2
    v_mul_u32_u24 v24, 13088, v6
    v_and_b32 v6, 3, v1
    v_lshl_add_u32 v24, v6, 3, v24
    v_lshl_add_u32 v24, v3, 7, v24
    s_lshl_b32 s7, s3, 10
    s_add_u32 s7, s7, 111488
    v_add_u32 v24, s7, v24
    v_lshlrev_b32 v21, 7, v2
    s_lshl_b32 s5, s3, 11
    s_add_u32 s5, s5, 77824
    s_lshl_b32 s7, s3, 12
    v_lshlrev_b32 v26, 9, v3
    v_lshl_add_u32 v26, v2, 4, v26
    v_add_u32 v26, s7, v26
    v_min_u32 v25, 2, v1
    v_lshlrev_b32 v25, 11, v25
    s_lshl_b32 s6, s69, 7
    s_add_u32 s6, s6, 86016
    s_lshl_b32 s91, s3, 10
    s_mul_i32 s97, s69, 129024
    s_add_u32 s97, s97, 3293184
    s_waitcnt vmcnt(0)
    ds_read_b128 a[32:35], v10 offset:3584
    ds_read_b128 a[36:39], v10 offset:3072
    ds_read_b128 a[40:43], v10 offset:2560
    ds_read_b128 a[44:47], v10 offset:2048
    ds_read_b128 a[48:51], v10 offset:1536
    ds_read_b128 a[52:55], v10 offset:1024
    ds_read_b128 a[56:59], v10 offset:512
    ds_read_b128 a[60:63], v10 offset:0
    s_waitcnt lgkmcnt(7)
    v_mfma_f32_16x16x32_bf16 v[32:35], v[16:19], a[32:35], 0
    s_waitcnt lgkmcnt(6)
    v_mfma_f32_16x16x32_bf16 v[36:39], v[16:19], a[36:39], 0
    s_waitcnt lgkmcnt(5)
    v_mfma_f32_16x16x32_bf16 v[40:43], v[16:19], a[40:43], 0
    s_waitcnt lgkmcnt(4)
    v_mfma_f32_16x16x32_bf16 v[44:47], v[16:19], a[44:47], 0
    s_waitcnt lgkmcnt(3)
    v_mfma_f32_16x16x32_bf16 v[48:51], v[16:19], a[48:51], 0
    s_waitcnt lgkmcnt(2)
    v_mfma_f32_16x16x32_bf16 v[52:55], v[16:19], a[52:55], 0
    s_waitcnt lgkmcnt(1)
    v_mfma_f32_16x16x32_bf16 v[56:59], v[16:19], a[56:59], 0
    s_waitcnt lgkmcnt(0)
    v_mfma_f32_16x16x32_bf16 v[60:63], v[16:19], a[60:63], 0
    v_mfma_f32_16x16x32_bf16 v[32:35], a[0:3], a[32:35], v[32:35]
    ds_read_b128 a[96:99], v10 offset:3648
    v_mfma_f32_16x16x32_bf16 v[36:39], a[0:3], a[36:39], v[36:39]
    buffer_load_dword v30, v25, s[44:47], s6 offen offset:12 sc1
    v_mfma_f32_16x16x32_bf16 v[40:43], a[0:3], a[40:43], v[40:43]
    ds_read2_b32 a[64:65], v12 offset0:16 offset1:17
    ds_read2_b32 a[66:67], v12 offset0:18 offset1:19
    v_mfma_f32_16x16x32_bf16 v[44:47], a[0:3], a[44:47], v[44:47]
    v_mfma_f32_16x16x32_bf16 v[48:51], a[0:3], a[48:51], v[48:51]
    ds_read_b128 a[100:103], v10 offset:3136
    v_mfma_f32_16x16x32_bf16 v[52:55], a[0:3], a[52:55], v[52:55]
    v_mfma_f32_16x16x32_bf16 v[56:59], a[0:3], a[56:59], v[56:59]
    ds_read2_b32 a[68:69], v12 offset0:144 offset1:145
    ds_read2_b32 a[70:71], v12 offset0:146 offset1:147
    v_mfma_f32_16x16x32_bf16 v[60:63], a[0:3], a[60:63], v[60:63]
    v_mfma_f32_16x16x32_bf16 v[36:39], a[4:7], a[32:35], v[36:39]
    ds_read_b128 a[104:107], v10 offset:2624
    v_mfma_f32_16x16x32_bf16 v[40:43], a[4:7], a[36:39], v[40:43]
    v_mfma_f32_16x16x32_bf16 v[44:47], a[4:7], a[40:43], v[44:47]
    ds_read2_b32 a[72:73], v13 offset0:16 offset1:17
    ds_read2_b32 a[74:75], v13 offset0:18 offset1:19
    v_mfma_f32_16x16x32_bf16 v[48:51], a[4:7], a[44:47], v[48:51]
    v_mfma_f32_16x16x32_bf16 v[52:55], a[4:7], a[48:51], v[52:55]
    ds_read_b128 a[108:111], v10 offset:2112
    v_mfma_f32_16x16x32_bf16 v[56:59], a[4:7], a[52:55], v[56:59]
    v_mfma_f32_16x16x32_bf16 v[60:63], a[4:7], a[56:59], v[60:63]
    ds_read2_b32 a[76:77], v13 offset0:144 offset1:145
    ds_read2_b32 a[78:79], v13 offset0:146 offset1:147
    v_mfma_f32_16x16x32_bf16 v[40:43], a[8:11], a[32:35], v[40:43]
    v_mfma_f32_16x16x32_bf16 v[44:47], a[8:11], a[36:39], v[44:47]
    ds_read_b128 a[112:115], v10 offset:1600
    v_mfma_f32_16x16x32_bf16 v[48:51], a[8:11], a[40:43], v[48:51]
    v_mfma_f32_16x16x32_bf16 v[52:55], a[8:11], a[44:47], v[52:55]
    ds_read2_b32 a[80:81], v14 offset0:16 offset1:17
    ds_read2_b32 a[82:83], v14 offset0:18 offset1:19
    v_mfma_f32_16x16x32_bf16 v[56:59], a[8:11], a[48:51], v[56:59]
    v_mfma_f32_16x16x32_bf16 v[60:63], a[8:11], a[52:55], v[60:63]
    ds_read_b128 a[116:119], v10 offset:1088
    v_mfma_f32_16x16x32_bf16 v[44:47], a[12:15], a[32:35], v[44:47]
    v_mfma_f32_16x16x32_bf16 v[48:51], a[12:15], a[36:39], v[48:51]
    ds_read2_b32 a[84:85], v14 offset0:144 offset1:145
    ds_read2_b32 a[86:87], v14 offset0:146 offset1:147
    v_mfma_f32_16x16x32_bf16 v[52:55], a[12:15], a[40:43], v[52:55]
    v_mfma_f32_16x16x32_bf16 v[56:59], a[12:15], a[44:47], v[56:59]
    ds_read_b128 a[120:123], v10 offset:576
    v_mfma_f32_16x16x32_bf16 v[60:63], a[12:15], a[48:51], v[60:63]
    v_mfma_f32_16x16x32_bf16 v[48:51], a[16:19], a[32:35], v[48:51]
    ds_read2_b32 a[88:89], v15 offset0:16 offset1:17
    ds_read2_b32 a[90:91], v15 offset0:18 offset1:19
    v_mfma_f32_16x16x32_bf16 v[52:55], a[16:19], a[36:39], v[52:55]
    v_mfma_f32_16x16x32_bf16 v[56:59], a[16:19], a[40:43], v[56:59]
    ds_read_b128 a[124:127], v10 offset:64
    v_mfma_f32_16x16x32_bf16 v[60:63], a[16:19], a[44:47], v[60:63]
    v_mfma_f32_16x16x32_bf16 v[52:55], a[20:23], a[32:35], v[52:55]
    ds_read2_b32 a[92:93], v15 offset0:144 offset1:145
    ds_read2_b32 a[94:95], v15 offset0:146 offset1:147
    v_mfma_f32_16x16x32_bf16 v[56:59], a[20:23], a[36:39], v[56:59]
    v_mfma_f32_16x16x32_bf16 v[60:63], a[20:23], a[40:43], v[60:63]
    v_mfma_f32_16x16x32_bf16 v[56:59], a[24:27], a[32:35], v[56:59]
    v_mfma_f32_16x16x32_bf16 v[60:63], a[24:27], a[36:39], v[60:63]
    v_mfma_f32_16x16x32_bf16 v[60:63], a[28:31], a[32:35], v[60:63]
    s_waitcnt lgkmcnt(0)
    v_mfma_f32_16x16x32_bf16 v[32:35], a[64:67], a[96:99], v[32:35]
    ds_read_b128 a[32:35], v10 offset:3712
    v_mfma_f32_16x16x32_bf16 v[36:39], a[64:67], a[100:103], v[36:39]
    buffer_load_dword v31, v25, s[44:47], s6 offen offset:12 sc1
    v_mfma_f32_16x16x32_bf16 v[40:43], a[64:67], a[104:107], v[40:43]
    ds_read2_b32 a[0:1], v12 offset0:32 offset1:33
    ds_read2_b32 a[2:3], v12 offset0:34 offset1:35
    v_mfma_f32_16x16x32_bf16 v[44:47], a[64:67], a[108:111], v[44:47]
    v_mfma_f32_16x16x32_bf16 v[48:51], a[64:67], a[112:115], v[48:51]
    ds_read_b128 a[36:39], v10 offset:3200
    v_mfma_f32_16x16x32_bf16 v[52:55], a[64:67], a[116:119], v[52:55]
    v_mfma_f32_16x16x32_bf16 v[56:59], a[64:67], a[120:123], v[56:59]
    ds_read2_b32 a[4:5], v12 offset0:160 offset1:161
    ds_read2_b32 a[6:7], v12 offset0:162 offset1:163
    v_mfma_f32_16x16x32_bf16 v[60:63], a[64:67], a[124:127], v[60:63]
    v_mfma_f32_16x16x32_bf16 v[36:39], a[68:71], a[96:99], v[36:39]
    ds_read_b128 a[40:43], v10 offset:2688
    v_mfma_f32_16x16x32_bf16 v[40:43], a[68:71], a[100:103], v[40:43]
    v_mfma_f32_16x16x32_bf16 v[44:47], a[68:71], a[104:107], v[44:47]
    ds_read2_b32 a[8:9], v13 offset0:32 offset1:33
    ds_read2_b32 a[10:11], v13 offset0:34 offset1:35
    v_mfma_f32_16x16x32_bf16 v[48:51], a[68:71], a[108:111], v[48:51]
    v_mfma_f32_16x16x32_bf16 v[52:55], a[68:71], a[112:115], v[52:55]
    ds_read_b128 a[44:47], v10 offset:2176
    v_mfma_f32_16x16x32_bf16 v[56:59], a[68:71], a[116:119], v[56:59]
    v_mfma_f32_16x16x32_bf16 v[60:63], a[68:71], a[120:123], v[60:63]
    ds_read2_b32 a[12:13], v13 offset0:160 offset1:161
    ds_read2_b32 a[14:15], v13 offset0:162 offset1:163
    v_mfma_f32_16x16x32_bf16 v[40:43], a[72:75], a[96:99], v[40:43]
    v_mfma_f32_16x16x32_bf16 v[44:47], a[72:75], a[100:103], v[44:47]
    ds_read_b128 a[48:51], v10 offset:1664
    v_mfma_f32_16x16x32_bf16 v[48:51], a[72:75], a[104:107], v[48:51]
    v_mfma_f32_16x16x32_bf16 v[52:55], a[72:75], a[108:111], v[52:55]
    ds_read2_b32 a[16:17], v14 offset0:32 offset1:33
    ds_read2_b32 a[18:19], v14 offset0:34 offset1:35
    v_mfma_f32_16x16x32_bf16 v[56:59], a[72:75], a[112:115], v[56:59]
    v_mfma_f32_16x16x32_bf16 v[60:63], a[72:75], a[116:119], v[60:63]
    ds_read_b128 a[52:55], v10 offset:1152
    v_mfma_f32_16x16x32_bf16 v[44:47], a[76:79], a[96:99], v[44:47]
    v_mfma_f32_16x16x32_bf16 v[48:51], a[76:79], a[100:103], v[48:51]
    ds_read2_b32 a[20:21], v14 offset0:160 offset1:161
    ds_read2_b32 a[22:23], v14 offset0:162 offset1:163
    v_mfma_f32_16x16x32_bf16 v[52:55], a[76:79], a[104:107], v[52:55]
    v_mfma_f32_16x16x32_bf16 v[56:59], a[76:79], a[108:111], v[56:59]
    ds_read_b128 a[56:59], v10 offset:640
    v_mfma_f32_16x16x32_bf16 v[60:63], a[76:79], a[112:115], v[60:63]
    v_mfma_f32_16x16x32_bf16 v[48:51], a[80:83], a[96:99], v[48:51]
    ds_read2_b32 a[24:25], v15 offset0:32 offset1:33
    ds_read2_b32 a[26:27], v15 offset0:34 offset1:35
    v_mfma_f32_16x16x32_bf16 v[52:55], a[80:83], a[100:103], v[52:55]
    v_mfma_f32_16x16x32_bf16 v[56:59], a[80:83], a[104:107], v[56:59]
    ds_read_b128 a[60:63], v10 offset:128
    v_mfma_f32_16x16x32_bf16 v[60:63], a[80:83], a[108:111], v[60:63]
    v_mfma_f32_16x16x32_bf16 v[52:55], a[84:87], a[96:99], v[52:55]
    ds_read2_b32 a[28:29], v15 offset0:160 offset1:161
    ds_read2_b32 a[30:31], v15 offset0:162 offset1:163
    v_mfma_f32_16x16x32_bf16 v[56:59], a[84:87], a[100:103], v[56:59]
    v_mfma_f32_16x16x32_bf16 v[60:63], a[84:87], a[104:107], v[60:63]
    v_mfma_f32_16x16x32_bf16 v[56:59], a[88:91], a[96:99], v[56:59]
    v_mfma_f32_16x16x32_bf16 v[60:63], a[88:91], a[100:103], v[60:63]
    v_mfma_f32_16x16x32_bf16 v[60:63], a[92:95], a[96:99], v[60:63]
    s_waitcnt lgkmcnt(0)
    v_mfma_f32_16x16x32_bf16 v[32:35], a[0:3], a[32:35], v[32:35]
    ds_read_b128 a[96:99], v10 offset:3776
    v_mfma_f32_16x16x32_bf16 v[36:39], a[0:3], a[36:39], v[36:39]
    s_waitcnt vmcnt(1)
    v_cmp_ne_u32 vcc, s4, v30
    s_nop 0
    v_mfma_f32_16x16x32_bf16 v[40:43], a[0:3], a[40:43], v[40:43]
    ds_read2_b32 a[64:65], v12 offset0:48 offset1:49
    ds_read2_b32 a[66:67], v12 offset0:50 offset1:51
    v_mfma_f32_16x16x32_bf16 v[44:47], a[0:3], a[44:47], v[44:47]
    s_cmp_eq_u64 vcc, 0
    s_cselect_b32 s95, 4096, 0
    s_cselect_b32 s96, s97, 0x7f000000
    v_mfma_f32_16x16x32_bf16 v[48:51], a[0:3], a[48:51], v[48:51]
    ds_read_b128 a[100:103], v10 offset:3264
    v_mfma_f32_16x16x32_bf16 v[52:55], a[0:3], a[52:55], v[52:55]
    buffer_load_dword v30, v25, s[44:47], s6 offen offset:12 sc1
    s_add_u32 s92, s96, s91
    v_mfma_f32_16x16x32_bf16 v[56:59], a[0:3], a[56:59], v[56:59]
    ds_read2_b32 a[68:69], v12 offset0:176 offset1:177
    ds_read2_b32 a[70:71], v12 offset0:178 offset1:179
    v_mfma_f32_16x16x32_bf16 v[60:63], a[0:3], a[60:63], v[60:63]
    s_mov_b32 m0, s91
    s_add_u32 s91, s91, s95
    v_mfma_f32_16x16x32_bf16 v[36:39], a[4:7], a[32:35], v[36:39]
    ds_read_b128 a[104:107], v10 offset:2752
    v_mfma_f32_16x16x32_bf16 v[40:43], a[4:7], a[36:39], v[40:43]
    buffer_load_dwordx4 v4, s[44:47], s92 offen sc1 lds
    s_add_u32 s92, s96, s91
    v_mfma_f32_16x16x32_bf16 v[44:47], a[4:7], a[40:43], v[44:47]
    ds_read2_b32 a[72:73], v13 offset0:48 offset1:49
    ds_read2_b32 a[74:75], v13 offset0:50 offset1:51
    v_mfma_f32_16x16x32_bf16 v[48:51], a[4:7], a[44:47], v[48:51]
    s_mov_b32 m0, s91
    s_add_u32 s91, s91, s95
    v_mfma_f32_16x16x32_bf16 v[52:55], a[4:7], a[48:51], v[52:55]
    ds_read_b128 a[108:111], v10 offset:2240
    v_mfma_f32_16x16x32_bf16 v[56:59], a[4:7], a[52:55], v[56:59]
    buffer_load_dwordx4 v4, s[44:47], s92 offen sc1 lds
    s_add_u32 s92, s96, s91
    v_mfma_f32_16x16x32_bf16 v[60:63], a[4:7], a[56:59], v[60:63]
    ds_read2_b32 a[76:77], v13 offset0:176 offset1:177
    ds_read2_b32 a[78:79], v13 offset0:178 offset1:179
    v_mfma_f32_16x16x32_bf16 v[40:43], a[8:11], a[32:35], v[40:43]
    s_mov_b32 m0, s91
    s_add_u32 s91, s91, s95
    v_mfma_f32_16x16x32_bf16 v[44:47], a[8:11], a[36:39], v[44:47]
    ds_read_b128 a[112:115], v10 offset:1728
    v_mfma_f32_16x16x32_bf16 v[48:51], a[8:11], a[40:43], v[48:51]
    buffer_load_dwordx4 v4, s[44:47], s92 offen sc1 lds
    s_add_u32 s92, s96, s91
    v_mfma_f32_16x16x32_bf16 v[52:55], a[8:11], a[44:47], v[52:55]
    ds_read2_b32 a[80:81], v14 offset0:48 offset1:49
    ds_read2_b32 a[82:83], v14 offset0:50 offset1:51
    v_mfma_f32_16x16x32_bf16 v[56:59], a[8:11], a[48:51], v[56:59]
    s_mov_b32 m0, s91
    s_add_u32 s91, s91, s95
    v_mfma_f32_16x16x32_bf16 v[60:63], a[8:11], a[52:55], v[60:63]
    ds_read_b128 a[116:119], v10 offset:1216
    v_mfma_f32_16x16x32_bf16 v[44:47], a[12:15], a[32:35], v[44:47]
    buffer_load_dwordx4 v4, s[44:47], s92 offen sc1 lds
    s_add_u32 s92, s96, s91
    v_mfma_f32_16x16x32_bf16 v[48:51], a[12:15], a[36:39], v[48:51]
    ds_read2_b32 a[84:85], v14 offset0:176 offset1:177
    ds_read2_b32 a[86:87], v14 offset0:178 offset1:179
    v_mfma_f32_16x16x32_bf16 v[52:55], a[12:15], a[40:43], v[52:55]
    s_mov_b32 m0, s91
    s_add_u32 s91, s91, s95
    v_mfma_f32_16x16x32_bf16 v[56:59], a[12:15], a[44:47], v[56:59]
    ds_read_b128 a[120:123], v10 offset:704
    v_mfma_f32_16x16x32_bf16 v[60:63], a[12:15], a[48:51], v[60:63]
    buffer_load_dwordx4 v4, s[44:47], s92 offen sc1 lds
    v_mfma_f32_16x16x32_bf16 v[48:51], a[16:19], a[32:35], v[48:51]
    ds_read2_b32 a[88:89], v15 offset0:48 offset1:49
    ds_read2_b32 a[90:91], v15 offset0:50 offset1:51
    v_mfma_f32_16x16x32_bf16 v[52:55], a[16:19], a[36:39], v[52:55]
    v_mfma_f32_16x16x32_bf16 v[56:59], a[16:19], a[40:43], v[56:59]
    ds_read_b128 a[124:127], v10 offset:192
    v_mfma_f32_16x16x32_bf16 v[60:63], a[16:19], a[44:47], v[60:63]
    v_mfma_f32_16x16x32_bf16 v[52:55], a[20:23], a[32:35], v[52:55]
    ds_read2_b32 a[92:93], v15 offset0:176 offset1:177
    ds_read2_b32 a[94:95], v15 offset0:178 offset1:179
    v_mfma_f32_16x16x32_bf16 v[56:59], a[20:23], a[36:39], v[56:59]
    v_mfma_f32_16x16x32_bf16 v[60:63], a[20:23], a[40:43], v[60:63]
    v_mfma_f32_16x16x32_bf16 v[56:59], a[24:27], a[32:35], v[56:59]
    v_mfma_f32_16x16x32_bf16 v[60:63], a[24:27], a[36:39], v[60:63]
    v_mfma_f32_16x16x32_bf16 v[60:63], a[28:31], a[32:35], v[60:63]
    s_waitcnt lgkmcnt(0)
    v_mfma_f32_16x16x32_bf16 v[32:35], a[64:67], a[96:99], v[32:35]
    ds_read_b128 a[32:35], v10 offset:3840
    v_mfma_f32_16x16x32_bf16 v[36:39], a[64:67], a[100:103], v[36:39]
    s_waitcnt vmcnt(6)
    v_cmp_ne_u32 vcc, s4, v31
    s_nop 0
    v_mfma_f32_16x16x32_bf16 v[40:43], a[64:67], a[104:107], v[40:43]
    ds_read2_b32 a[0:1], v12 offset0:64 offset1:65
    ds_read2_b32 a[2:3], v12 offset0:66 offset1:67
    v_mfma_f32_16x16x32_bf16 v[44:47], a[64:67], a[108:111], v[44:47]
    s_cmp_eq_u64 vcc, 0
    s_cselect_b32 s95, 4096, 0
    s_cselect_b32 s96, s97, 0x7f000000
    v_mfma_f32_16x16x32_bf16 v[48:51], a[64:67], a[112:115], v[48:51]
    ds_read_b128 a[36:39], v10 offset:3328
    v_mfma_f32_16x16x32_bf16 v[52:55], a[64:67], a[116:119], v[52:55]
    buffer_load_dword v31, v25, s[44:47], s6 offen offset:12 sc1
    buffer_load_dword v20, v21, s[44:47], s5 offen offset:12 sc1
    v_mfma_f32_16x16x32_bf16 v[56:59], a[64:67], a[120:123], v[56:59]
    ds_read2_b32 a[4:5], v12 offset0:192 offset1:193
    ds_read2_b32 a[6:7], v12 offset0:194 offset1:195
    v_mfma_f32_16x16x32_bf16 v[60:63], a[64:67], a[124:127], v[60:63]
    s_add_u32 s92, s96, s91
    s_mov_b32 m0, s91
    v_mfma_f32_16x16x32_bf16 v[36:39], a[68:71], a[96:99], v[36:39]
    ds_read_b128 a[40:43], v10 offset:2816
    v_mfma_f32_16x16x32_bf16 v[40:43], a[68:71], a[100:103], v[40:43]
    s_add_u32 s91, s91, s95
    buffer_load_dwordx4 v4, s[44:47], s92 offen sc1 lds
    v_mfma_f32_16x16x32_bf16 v[44:47], a[68:71], a[104:107], v[44:47]
    ds_read2_b32 a[8:9], v13 offset0:64 offset1:65
    ds_read2_b32 a[10:11], v13 offset0:66 offset1:67
    v_mfma_f32_16x16x32_bf16 v[48:51], a[68:71], a[108:111], v[48:51]
    s_add_u32 s92, s96, s91
    s_mov_b32 m0, s91
    v_mfma_f32_16x16x32_bf16 v[52:55], a[68:71], a[112:115], v[52:55]
    ds_read_b128 a[44:47], v10 offset:2304
    v_mfma_f32_16x16x32_bf16 v[56:59], a[68:71], a[116:119], v[56:59]
    s_add_u32 s91, s91, s95
    buffer_load_dwordx4 v4, s[44:47], s92 offen sc1 lds
    v_mfma_f32_16x16x32_bf16 v[60:63], a[68:71], a[120:123], v[60:63]
    ds_read2_b32 a[12:13], v13 offset0:192 offset1:193
    ds_read2_b32 a[14:15], v13 offset0:194 offset1:195
    v_mfma_f32_16x16x32_bf16 v[40:43], a[72:75], a[96:99], v[40:43]
    s_add_u32 s92, s96, s91
    s_mov_b32 m0, s91
    v_mfma_f32_16x16x32_bf16 v[44:47], a[72:75], a[100:103], v[44:47]
    ds_read_b128 a[48:51], v10 offset:1792
    v_mfma_f32_16x16x32_bf16 v[48:51], a[72:75], a[104:107], v[48:51]
    s_add_u32 s91, s91, s95
    buffer_load_dwordx4 v4, s[44:47], s92 offen sc1 lds
    v_mfma_f32_16x16x32_bf16 v[52:55], a[72:75], a[108:111], v[52:55]
    ds_read2_b32 a[16:17], v14 offset0:64 offset1:65
    ds_read2_b32 a[18:19], v14 offset0:66 offset1:67
    v_mfma_f32_16x16x32_bf16 v[56:59], a[72:75], a[112:115], v[56:59]
    s_add_u32 s92, s96, s91
    s_mov_b32 m0, s91
    v_mfma_f32_16x16x32_bf16 v[60:63], a[72:75], a[116:119], v[60:63]
    ds_read_b128 a[52:55], v10 offset:1280
    v_mfma_f32_16x16x32_bf16 v[44:47], a[76:79], a[96:99], v[44:47]
    s_add_u32 s91, s91, s95
    buffer_load_dwordx4 v4, s[44:47], s92 offen sc1 lds
    v_mfma_f32_16x16x32_bf16 v[48:51], a[76:79], a[100:103], v[48:51]
    ds_read2_b32 a[20:21], v14 offset0:192 offset1:193
    ds_read2_b32 a[22:23], v14 offset0:194 offset1:195
    v_mfma_f32_16x16x32_bf16 v[52:55], a[76:79], a[104:107], v[52:55]
    s_add_u32 s92, s96, s91
    s_mov_b32 m0, s91
    v_mfma_f32_16x16x32_bf16 v[56:59], a[76:79], a[108:111], v[56:59]
    ds_read_b128 a[56:59], v10 offset:768
    v_mfma_f32_16x16x32_bf16 v[60:63], a[76:79], a[112:115], v[60:63]
    s_add_u32 s91, s91, s95
    buffer_load_dwordx4 v4, s[44:47], s92 offen sc1 lds
    v_mfma_f32_16x16x32_bf16 v[48:51], a[80:83], a[96:99], v[48:51]
    ds_read2_b32 a[24:25], v15 offset0:64 offset1:65
    ds_read2_b32 a[26:27], v15 offset0:66 offset1:67
    v_mfma_f32_16x16x32_bf16 v[52:55], a[80:83], a[100:103], v[52:55]
    s_add_u32 s92, s96, s91
    s_mov_b32 m0, s91
    v_mfma_f32_16x16x32_bf16 v[56:59], a[80:83], a[104:107], v[56:59]
    ds_read_b128 a[60:63], v10 offset:256
    v_mfma_f32_16x16x32_bf16 v[60:63], a[80:83], a[108:111], v[60:63]
    s_add_u32 s91, s91, s95
    buffer_load_dwordx4 v4, s[44:47], s92 offen sc1 lds
    v_mfma_f32_16x16x32_bf16 v[52:55], a[84:87], a[96:99], v[52:55]
    ds_read2_b32 a[28:29], v15 offset0:192 offset1:193
    ds_read2_b32 a[30:31], v15 offset0:194 offset1:195
    v_mfma_f32_16x16x32_bf16 v[56:59], a[84:87], a[100:103], v[56:59]
    v_mfma_f32_16x16x32_bf16 v[60:63], a[84:87], a[104:107], v[60:63]
    v_mfma_f32_16x16x32_bf16 v[56:59], a[88:91], a[96:99], v[56:59]
    v_mfma_f32_16x16x32_bf16 v[60:63], a[88:91], a[100:103], v[60:63]
    v_mfma_f32_16x16x32_bf16 v[60:63], a[92:95], a[96:99], v[60:63]
    s_waitcnt lgkmcnt(0)
    v_mfma_f32_16x16x32_bf16 v[32:35], a[0:3], a[32:35], v[32:35]
    ds_read_b128 a[96:99], v10 offset:3904
    v_mfma_f32_16x16x32_bf16 v[36:39], a[0:3], a[36:39], v[36:39]
    s_waitcnt vmcnt(13)
    v_cmp_ne_u32 vcc, s4, v30
    s_nop 0
    v_mfma_f32_16x16x32_bf16 v[40:43], a[0:3], a[40:43], v[40:43]
    ds_read2_b32 a[64:65], v12 offset0:80 offset1:81
    ds_read2_b32 a[66:67], v12 offset0:82 offset1:83
    v_mfma_f32_16x16x32_bf16 v[44:47], a[0:3], a[44:47], v[44:47]
    s_cmp_eq_u64 vcc, 0
    s_cselect_b32 s95, 4096, 0
    s_cselect_b32 s96, s97, 0x7f000000
    v_mfma_f32_16x16x32_bf16 v[48:51], a[0:3], a[48:51], v[48:51]
    ds_read_b128 a[100:103], v10 offset:3392
    v_mfma_f32_16x16x32_bf16 v[52:55], a[0:3], a[52:55], v[52:55]
    buffer_load_dword v30, v25, s[44:47], s6 offen offset:12 sc1
    s_add_u32 s92, s96, s91
    v_mfma_f32_16x16x32_bf16 v[56:59], a[0:3], a[56:59], v[56:59]
    ds_read2_b32 a[68:69], v12 offset0:208 offset1:209
    ds_read2_b32 a[70:71], v12 offset0:210 offset1:211
    v_mfma_f32_16x16x32_bf16 v[60:63], a[0:3], a[60:63], v[60:63]
    s_mov_b32 m0, s91
    s_add_u32 s91, s91, s95
    v_mfma_f32_16x16x32_bf16 v[36:39], a[4:7], a[32:35], v[36:39]
    ds_read_b128 a[104:107], v10 offset:2880
    v_mfma_f32_16x16x32_bf16 v[40:43], a[4:7], a[36:39], v[40:43]
    buffer_load_dwordx4 v4, s[44:47], s92 offen sc1 lds
    s_add_u32 s92, s96, s91
    v_mfma_f32_16x16x32_bf16 v[44:47], a[4:7], a[40:43], v[44:47]
    ds_read2_b32 a[72:73], v13 offset0:80 offset1:81
    ds_read2_b32 a[74:75], v13 offset0:82 offset1:83
    v_mfma_f32_16x16x32_bf16 v[48:51], a[4:7], a[44:47], v[48:51]
    s_mov_b32 m0, s91
    s_add_u32 s91, s91, s95
    v_mfma_f32_16x16x32_bf16 v[52:55], a[4:7], a[48:51], v[52:55]
    ds_read_b128 a[108:111], v10 offset:2368
    v_mfma_f32_16x16x32_bf16 v[56:59], a[4:7], a[52:55], v[56:59]
    buffer_load_dwordx4 v4, s[44:47], s92 offen sc1 lds
    s_add_u32 s92, s96, s91
    v_mfma_f32_16x16x32_bf16 v[60:63], a[4:7], a[56:59], v[60:63]
    ds_read2_b32 a[76:77], v13 offset0:208 offset1:209
    ds_read2_b32 a[78:79], v13 offset0:210 offset1:211
    v_mfma_f32_16x16x32_bf16 v[40:43], a[8:11], a[32:35], v[40:43]
    s_mov_b32 m0, s91
    s_add_u32 s91, s91, s95
    v_mfma_f32_16x16x32_bf16 v[44:47], a[8:11], a[36:39], v[44:47]
    ds_read_b128 a[112:115], v10 offset:1856
    v_mfma_f32_16x16x32_bf16 v[48:51], a[8:11], a[40:43], v[48:51]
    buffer_load_dwordx4 v4, s[44:47], s92 offen sc1 lds
    s_add_u32 s92, s96, s91
    v_mfma_f32_16x16x32_bf16 v[52:55], a[8:11], a[44:47], v[52:55]
    ds_read2_b32 a[80:81], v14 offset0:80 offset1:81
    ds_read2_b32 a[82:83], v14 offset0:82 offset1:83
    v_mfma_f32_16x16x32_bf16 v[56:59], a[8:11], a[48:51], v[56:59]
    s_mov_b32 m0, s91
    s_add_u32 s91, s91, s95
    v_mfma_f32_16x16x32_bf16 v[60:63], a[8:11], a[52:55], v[60:63]
    ds_read_b128 a[116:119], v10 offset:1344
    v_mfma_f32_16x16x32_bf16 v[44:47], a[12:15], a[32:35], v[44:47]
    buffer_load_dwordx4 v4, s[44:47], s92 offen sc1 lds
    s_add_u32 s92, s96, s91
    v_mfma_f32_16x16x32_bf16 v[48:51], a[12:15], a[36:39], v[48:51]
    ds_read2_b32 a[84:85], v14 offset0:208 offset1:209
    ds_read2_b32 a[86:87], v14 offset0:210 offset1:211
    v_mfma_f32_16x16x32_bf16 v[52:55], a[12:15], a[40:43], v[52:55]
    s_mov_b32 m0, s91
    s_add_u32 s91, s91, s95
    v_mfma_f32_16x16x32_bf16 v[56:59], a[12:15], a[44:47], v[56:59]
    ds_read_b128 a[120:123], v10 offset:832
    v_mfma_f32_16x16x32_bf16 v[60:63], a[12:15], a[48:51], v[60:63]
    buffer_load_dwordx4 v4, s[44:47], s92 offen sc1 lds
    s_add_u32 s92, s96, s91
    v_mfma_f32_16x16x32_bf16 v[48:51], a[16:19], a[32:35], v[48:51]
    ds_read2_b32 a[88:89], v15 offset0:80 offset1:81
    ds_read2_b32 a[90:91], v15 offset0:82 offset1:83
    v_mfma_f32_16x16x32_bf16 v[52:55], a[16:19], a[36:39], v[52:55]
    s_mov_b32 m0, s91
    s_add_u32 s91, s91, s95
    v_mfma_f32_16x16x32_bf16 v[56:59], a[16:19], a[40:43], v[56:59]
    ds_read_b128 a[124:127], v10 offset:320
    v_mfma_f32_16x16x32_bf16 v[60:63], a[16:19], a[44:47], v[60:63]
    buffer_load_dwordx4 v4, s[44:47], s92 offen sc1 lds
    v_mfma_f32_16x16x32_bf16 v[52:55], a[20:23], a[32:35], v[52:55]
    ds_read2_b32 a[92:93], v15 offset0:208 offset1:209
    ds_read2_b32 a[94:95], v15 offset0:210 offset1:211
    v_mfma_f32_16x16x32_bf16 v[56:59], a[20:23], a[36:39], v[56:59]
    v_mfma_f32_16x16x32_bf16 v[60:63], a[20:23], a[40:43], v[60:63]
    v_mfma_f32_16x16x32_bf16 v[56:59], a[24:27], a[32:35], v[56:59]
    v_mfma_f32_16x16x32_bf16 v[60:63], a[24:27], a[36:39], v[60:63]
    v_mfma_f32_16x16x32_bf16 v[60:63], a[28:31], a[32:35], v[60:63]
    s_waitcnt lgkmcnt(0)
    s_waitcnt vmcnt(13)
    v_cmp_ne_u32 vcc, s4, v20
    s_nop 0
    s_cbranch_vccz L_skip_5
    s_mov_b64 exec, vcc
    s_mov_b32 s42, 400000
    s_nop 0
L_poll_6:
    buffer_load_dword v20, v21, s[44:47], s5 offen offset:12 sc1
    s_waitcnt vmcnt(0)
    v_cmp_ne_u32 vcc, s4, v20
    s_nop 1
    s_cbranch_vccz L_polld_7
    s_mov_b64 exec, vcc
    s_sub_u32 s42, s42, 1
    s_cbranch_scc0 L_poll_6
L_polld_7:
    s_mov_b64 exec, -1
L_skip_5:
    v_mfma_f32_16x16x32_bf16 v[32:35], a[64:67], a[96:99], v[32:35]
    ds_read_b128 a[32:35], v10 offset:3968
    v_mfma_f32_16x16x32_bf16 v[36:39], a[64:67], a[100:103], v[36:39]
    v_cmp_ne_u32 vcc, s4, v31
    s_nop 0
    v_mfma_f32_16x16x32_bf16 v[40:43], a[64:67], a[104:107], v[40:43]
    ds_read2_b32 a[0:1], v12 offset0:96 offset1:97
    ds_read2_b32 a[2:3], v12 offset0:98 offset1:99
    v_mfma_f32_16x16x32_bf16 v[44:47], a[64:67], a[108:111], v[44:47]
    s_cmp_eq_u64 vcc, 0
    s_cselect_b32 s95, 4096, 0
    s_cselect_b32 s96, s97, 0x7f000000
    v_mfma_f32_16x16x32_bf16 v[48:51], a[64:67], a[112:115], v[48:51]
    ds_read_b128 a[36:39], v10 offset:3456
    v_mfma_f32_16x16x32_bf16 v[52:55], a[64:67], a[116:119], v[52:55]
    buffer_load_dword v31, v25, s[44:47], s6 offen offset:12 sc1
    s_mov_b32 s7, 8683520
    v_mfma_f32_16x16x32_bf16 v[56:59], a[64:67], a[120:123], v[56:59]
    ds_read2_b32 a[4:5], v12 offset0:224 offset1:225
    ds_read2_b32 a[6:7], v12 offset0:226 offset1:227
    v_mfma_f32_16x16x32_bf16 v[60:63], a[64:67], a[124:127], v[60:63]
    buffer_load_dwordx4 v[64:67], v22, s[44:47], s7 offen sc1
    s_mov_b32 s7, 11042816
    v_mfma_f32_16x16x32_bf16 v[36:39], a[68:71], a[96:99], v[36:39]
    ds_read_b128 a[40:43], v10 offset:2944
    v_mfma_f32_16x16x32_bf16 v[40:43], a[68:71], a[100:103], v[40:43]
    buffer_load_dwordx4 v[80:83], v26, s[44:47], s7 offen sc1
    s_mov_b32 s7, 8720384
    v_mfma_f32_16x16x32_bf16 v[44:47], a[68:71], a[104:107], v[44:47]
    ds_read2_b32 a[8:9], v13 offset0:96 offset1:97
    ds_read2_b32 a[10:11], v13 offset0:98 offset1:99
    v_mfma_f32_16x16x32_bf16 v[48:51], a[68:71], a[108:111], v[48:51]
    buffer_load_dwordx4 v[68:71], v22, s[44:47], s7 offen sc1
    s_mov_b32 s7, 11043072
    v_mfma_f32_16x16x32_bf16 v[52:55], a[68:71], a[112:115], v[52:55]
    ds_read_b128 a[44:47], v10 offset:2432
    v_mfma_f32_16x16x32_bf16 v[56:59], a[68:71], a[116:119], v[56:59]
    buffer_load_dwordx4 v[84:87], v26, s[44:47], s7 offen sc1
    s_mov_b32 s7, 8978432
    v_mfma_f32_16x16x32_bf16 v[60:63], a[68:71], a[120:123], v[60:63]
    ds_read2_b32 a[12:13], v13 offset0:224 offset1:225
    ds_read2_b32 a[14:15], v13 offset0:226 offset1:227
    v_mfma_f32_16x16x32_bf16 v[40:43], a[72:75], a[96:99], v[40:43]
    buffer_load_dwordx4 v[72:75], v22, s[44:47], s7 offen sc1
    s_mov_b32 s7, 11044864
    v_mfma_f32_16x16x32_bf16 v[44:47], a[72:75], a[100:103], v[44:47]
    ds_read_b128 a[48:51], v10 offset:1920
    v_mfma_f32_16x16x32_bf16 v[48:51], a[72:75], a[104:107], v[48:51]
    buffer_load_dwordx4 v[88:91], v26, s[44:47], s7 offen sc1
    s_mov_b32 s7, 9015296
    v_mfma_f32_16x16x32_bf16 v[52:55], a[72:75], a[108:111], v[52:55]
    ds_read2_b32 a[16:17], v14 offset0:96 offset1:97
    ds_read2_b32 a[18:19], v14 offset0:98 offset1:99
    v_mfma_f32_16x16x32_bf16 v[56:59], a[72:75], a[112:115], v[56:59]
    buffer_load_dwordx4 v[76:79], v22, s[44:47], s7 offen sc1
    s_mov_b32 s7, 11045120
    v_mfma_f32_16x16x32_bf16 v[60:63], a[72:75], a[116:119], v[60:63]
    ds_read_b128 a[52:55], v10 offset:1408
    v_mfma_f32_16x16x32_bf16 v[44:47], a[76:79], a[96:99], v[44:47]
    buffer_load_dwordx4 v[92:95], v26, s[44:47], s7 offen sc1
    s_add_u32 s92, s96, s91
    v_mfma_f32_16x16x32_bf16 v[48:51], a[76:79], a[100:103], v[48:51]
    ds_read2_b32 a[20:21], v14 offset0:224 offset1:225
    ds_read2_b32 a[22:23], v14 offset0:226 offset1:227
    v_mfma_f32_16x16x32_bf16 v[52:55], a[76:79], a[104:107], v[52:55]
    s_mov_b32 m0, s91
    s_add_u32 s91, s91, s95
    v_mfma_f32_16x16x32_bf16 v[56:59], a[76:79], a[108:111], v[56:59]
    ds_read_b128 a[56:59], v10 offset:896
    v_mfma_f32_16x16x32_bf16 v[60:63], a[76:79], a[112:115], v[60:63]
    buffer_load_dwordx4 v4, s[44:47], s92 offen sc1 lds
    s_add_u32 s92, s96, s91
    v_mfma_f32_16x16x32_bf16 v[48:51], a[80:83], a[96:99], v[48:51]
    ds_read2_b32 a[24:25], v15 offset0:96 offset1:97
    ds_read2_b32 a[26:27], v15 offset0:98 offset1:99
    v_mfma_f32_16x16x32_bf16 v[52:55], a[80:83], a[100:103], v[52:55]
    s_mov_b32 m0, s91
    s_add_u32 s91, s91, s95
    v_mfma_f32_16x16x32_bf16 v[56:59], a[80:83], a[104:107], v[56:59]
    ds_read_b128 a[60:63], v10 offset:384
    v_mfma_f32_16x16x32_bf16 v[60:63], a[80:83], a[108:111], v[60:63]
    buffer_load_dwordx4 v4, s[44:47], s92 offen sc1 lds
    s_add_u32 s92, s96, s91
    v_mfma_f32_16x16x32_bf16 v[52:55], a[84:87], a[96:99], v[52:55]
    ds_read2_b32 a[28:29], v15 offset0:224 offset1:225
    ds_read2_b32 a[30:31], v15 offset0:226 offset1:227
    v_mfma_f32_16x16x32_bf16 v[56:59], a[84:87], a[100:103], v[56:59]
    s_mov_b32 m0, s91
    s_add_u32 s91, s91, s95
    v_mfma_f32_16x16x32_bf16 v[60:63], a[84:87], a[104:107], v[60:63]
    buffer_load_dwordx4 v4, s[44:47], s92 offen sc1 lds
    v_mfma_f32_16x16x32_bf16 v[56:59], a[88:91], a[96:99], v[56:59]
    v_mfma_f32_16x16x32_bf16 v[60:63], a[88:91], a[100:103], v[60:63]
    v_mfma_f32_16x16x32_bf16 v[60:63], a[92:95], a[96:99], v[60:63]
    s_waitcnt lgkmcnt(0)
    v_mfma_f32_16x16x32_bf16 v[32:35], a[0:3], a[32:35], v[32:35]
    ds_read_b128 a[96:99], v10 offset:4032
    v_mfma_f32_16x16x32_bf16 v[36:39], a[0:3], a[36:39], v[36:39]
    s_waitcnt vmcnt(18)
    v_cmp_ne_u32 vcc, s4, v30
    s_nop 0
    v_mfma_f32_16x16x32_bf16 v[40:43], a[0:3], a[40:43], v[40:43]
    ds_read2_b32 a[64:65], v12 offset0:112 offset1:113
    ds_read2_b32 a[66:67], v12 offset0:114 offset1:115
    v_mfma_f32_16x16x32_bf16 v[44:47], a[0:3], a[44:47], v[44:47]
    s_cmp_eq_u64 vcc, 0
    s_cselect_b32 s95, 4096, 0
    s_cselect_b32 s96, s97, 0x7f000000
    v_mfma_f32_16x16x32_bf16 v[48:51], a[0:3], a[48:51], v[48:51]
    ds_read_b128 a[100:103], v10 offset:3520
    v_mfma_f32_16x16x32_bf16 v[52:55], a[0:3], a[52:55], v[52:55]
    s_add_u32 s92, s96, s91
    s_mov_b32 m0, s91
    v_mfma_f32_16x16x32_bf16 v[56:59], a[0:3], a[56:59], v[56:59]
    ds_read2_b32 a[68:69], v12 offset0:240 offset1:241
    ds_read2_b32 a[70:71], v12 offset0:242 offset1:243
    v_mfma_f32_16x16x32_bf16 v[60:63], a[0:3], a[60:63], v[60:63]
    s_add_u32 s91, s91, s95
    buffer_load_dwordx4 v4, s[44:47], s92 offen sc1 lds
    v_mfma_f32_16x16x32_bf16 v[36:39], a[4:7], a[32:35], v[36:39]
    ds_read_b128 a[104:107], v10 offset:3008
    v_mfma_f32_16x16x32_bf16 v[40:43], a[4:7], a[36:39], v[40:43]
    s_add_u32 s92, s96, s91
    s_mov_b32 m0, s91
    v_mfma_f32_16x16x32_bf16 v[44:47], a[4:7], a[40:43], v[44:47]
    ds_read2_b32 a[72:73], v13 offset0:112 offset1:113
    ds_read2_b32 a[74:75], v13 offset0:114 offset1:115
    v_mfma_f32_16x16x32_bf16 v[48:51], a[4:7], a[44:47], v[48:51]
    s_add_u32 s91, s91, s95
    buffer_load_dwordx4 v4, s[44:47], s92 offen sc1 lds
    v_mfma_f32_16x16x32_bf16 v[52:55], a[4:7], a[48:51], v[52:55]
    ds_read_b128 a[108:111], v10 offset:2496
    v_mfma_f32_16x16x32_bf16 v[56:59], a[4:7], a[52:55], v[56:59]
    s_add_u32 s92, s96, s91
    s_mov_b32 m0, s91
    v_mfma_f32_16x16x32_bf16 v[60:63], a[4:7], a[56:59], v[60:63]
    ds_read2_b32 a[76:77], v13 offset0:240 offset1:241
    ds_read2_b32 a[78:79], v13 offset0:242 offset1:243
    v_mfma_f32_16x16x32_bf16 v[40:43], a[8:11], a[32:35], v[40:43]
    s_add_u32 s91, s91, s95
    buffer_load_dwordx4 v4, s[44:47], s92 offen sc1 lds
    v_mfma_f32_16x16x32_bf16 v[44:47], a[8:11], a[36:39], v[44:47]
    ds_read_b128 a[112:115], v10 offset:1984
    v_mfma_f32_16x16x32_bf16 v[48:51], a[8:11], a[40:43], v[48:51]
    s_add_u32 s92, s96, s91
    s_mov_b32 m0, s91
    v_mfma_f32_16x16x32_bf16 v[52:55], a[8:11], a[44:47], v[52:55]
    ds_read2_b32 a[80:81], v14 offset0:112 offset1:113
    ds_read2_b32 a[82:83], v14 offset0:114 offset1:115
    v_mfma_f32_16x16x32_bf16 v[56:59], a[8:11], a[48:51], v[56:59]
    s_add_u32 s91, s91, s95
    buffer_load_dwordx4 v4, s[44:47], s92 offen sc1 lds
    v_mfma_f32_16x16x32_bf16 v[60:63], a[8:11], a[52:55], v[60:63]
    ds_read_b128 a[116:119], v10 offset:1472
    v_mfma_f32_16x16x32_bf16 v[44:47], a[12:15], a[32:35], v[44:47]
    s_add_u32 s92, s96, s91
    s_mov_b32 m0, s91
    v_mfma_f32_16x16x32_bf16 v[48:51], a[12:15], a[36:39], v[48:51]
    ds_read2_b32 a[84:85], v14 offset0:240 offset1:241
    ds_read2_b32 a[86:87], v14 offset0:242 offset1:243
    v_mfma_f32_16x16x32_bf16 v[52:55], a[12:15], a[40:43], v[52:55]
    s_add_u32 s91, s91, s95
    buffer_load_dwordx4 v4, s[44:47], s92 offen sc1 lds
    v_mfma_f32_16x16x32_bf16 v[56:59], a[12:15], a[44:47], v[56:59]
    ds_read_b128 a[120:123], v10 offset:960
    v_mfma_f32_16x16x32_bf16 v[60:63], a[12:15], a[48:51], v[60:63]
    s_add_u32 s92, s96, s91
    s_mov_b32 m0, s91
    v_mfma_f32_16x16x32_bf16 v[48:51], a[16:19], a[32:35], v[48:51]
    ds_read2_b32 a[88:89], v15 offset0:112 offset1:113
    ds_read2_b32 a[90:91], v15 offset0:114 offset1:115
    v_mfma_f32_16x16x32_bf16 v[52:55], a[16:19], a[36:39], v[52:55]
    s_add_u32 s91, s91, s95
    buffer_load_dwordx4 v4, s[44:47], s92 offen sc1 lds
    v_mfma_f32_16x16x32_bf16 v[56:59], a[16:19], a[40:43], v[56:59]
    ds_read_b128 a[124:127], v10 offset:448
    v_mfma_f32_16x16x32_bf16 v[60:63], a[16:19], a[44:47], v[60:63]
    v_mfma_f32_16x16x32_bf16 v[52:55], a[20:23], a[32:35], v[52:55]
    ds_read2_b32 a[92:93], v15 offset0:240 offset1:241
    ds_read2_b32 a[94:95], v15 offset0:242 offset1:243
    v_mfma_f32_16x16x32_bf16 v[56:59], a[20:23], a[36:39], v[56:59]
    v_mfma_f32_16x16x32_bf16 v[60:63], a[20:23], a[40:43], v[60:63]
    v_mfma_f32_16x16x32_bf16 v[56:59], a[24:27], a[32:35], v[56:59]
    v_mfma_f32_16x16x32_bf16 v[60:63], a[24:27], a[36:39], v[60:63]
    v_mfma_f32_16x16x32_bf16 v[60:63], a[28:31], a[32:35], v[60:63]
    s_waitcnt lgkmcnt(0)
    v_mfma_f32_16x16x32_bf16 v[32:35], a[64:67], a[96:99], v[32:35]
    s_waitcnt vmcnt(17)
    v_cmp_ne_u32 vcc, s4, v31
    s_nop 0
    v_mfma_f32_16x16x32_bf16 v[36:39], a[64:67], a[100:103], v[36:39]
    s_cmp_eq_u64 vcc, 0
    s_cselect_b32 s95, 4096, 0
    s_cselect_b32 s96, s97, 0x7f000000
    v_mfma_f32_16x16x32_bf16 v[40:43], a[64:67], a[104:107], v[40:43]
    s_waitcnt vmcnt(16)
    v_lshlrev_b32 v178, 16, v64
    s_add_u32 s92, s96, s91
    v_mfma_f32_16x16x32_bf16 v[44:47], a[64:67], a[108:111], v[44:47]
    v_and_b32 v179, s101, v64
    s_mov_b32 m0, s91
    v_mfma_f32_16x16x32_bf16 v[48:51], a[64:67], a[112:115], v[48:51]
    v_lshlrev_b32 v182, 16, v65
    s_add_u32 s91, s91, s95
    v_mfma_f32_16x16x32_bf16 v[52:55], a[64:67], a[116:119], v[52:55]
    v_and_b32 v183, s101, v65
    buffer_load_dwordx4 v4, s[44:47], s92 offen sc1 lds
    v_mfma_f32_16x16x32_bf16 v[56:59], a[64:67], a[120:123], v[56:59]
    v_lshlrev_b32 v186, 16, v66
    v_and_b32 v187, s101, v66
    v_mfma_f32_16x16x32_bf16 v[60:63], a[64:67], a[124:127], v[60:63]
    v_lshlrev_b32 v190, 16, v67
    v_and_b32 v191, s101, v67
    v_mfma_f32_16x16x32_bf16 v[36:39], a[68:71], a[96:99], v[36:39]
    s_waitcnt vmcnt(16)
    v_fma_f32 v176, v178, v80, v81
    v_fma_f32 v177, v179, v80, v81
    v_mfma_f32_16x16x32_bf16 v[40:43], a[68:71], a[100:103], v[40:43]
    v_fma_f32 v180, v182, v80, v81
    v_fma_f32 v181, v183, v80, v81
    v_mfma_f32_16x16x32_bf16 v[44:47], a[68:71], a[104:107], v[44:47]
    v_fma_f32 v184, v186, v82, v83
    v_fma_f32 v185, v187, v82, v83
    v_mfma_f32_16x16x32_bf16 v[48:51], a[68:71], a[108:111], v[48:51]
    v_fma_f32 v188, v190, v82, v83
    v_fma_f32 v189, v191, v82, v83
    v_mfma_f32_16x16x32_bf16 v[52:55], a[68:71], a[112:115], v[52:55]
    s_waitcnt vmcnt(15)
    v_lshlrev_b32 v194, 16, v68
    v_and_b32 v195, s101, v68
    v_mfma_f32_16x16x32_bf16 v[56:59], a[68:71], a[116:119], v[56:59]
    v_lshlrev_b32 v198, 16, v69
    v_and_b32 v199, s101, v69
    v_mfma_f32_16x16x32_bf16 v[60:63], a[68:71], a[120:123], v[60:63]
    v_lshlrev_b32 v202, 16, v70
    v_and_b32 v203, s101, v70
    v_mfma_f32_16x16x32_bf16 v[40:43], a[72:75], a[96:99], v[40:43]
    v_lshlrev_b32 v206, 16, v71
    v_and_b32 v207, s101, v71
    v_mfma_f32_16x16x32_bf16 v[44:47], a[72:75], a[100:103], v[44:47]
    s_waitcnt vmcnt(14)
    v_fma_f32 v192, v194, v84, v85
    v_fma_f32 v193, v195, v84, v85
    v_mfma_f32_16x16x32_bf16 v[48:51], a[72:75], a[104:107], v[48:51]
    v_fma_f32 v196, v198, v84, v85
    v_fma_f32 v197, v199, v84, v85
    v_mfma_f32_16x16x32_bf16 v[52:55], a[72:75], a[108:111], v[52:55]
    v_fma_f32 v200, v202, v86, v87
    v_fma_f32 v201, v203, v86, v87
    v_mfma_f32_16x16x32_bf16 v[56:59], a[72:75], a[112:115], v[56:59]
    v_fma_f32 v204, v206, v86, v87
    v_fma_f32 v205, v207, v86, v87
    v_mfma_f32_16x16x32_bf16 v[60:63], a[72:75], a[116:119], v[60:63]
    s_waitcnt vmcnt(13)
    v_lshlrev_b32 v210, 16, v72
    v_and_b32 v211, s101, v72
    v_mfma_f32_16x16x32_bf16 v[44:47], a[76:79], a[96:99], v[44:47]
    v_lshlrev_b32 v214, 16, v73
    v_and_b32 v215, s101, v73
    v_mfma_f32_16x16x32_bf16 v[48:51], a[76:79], a[100:103], v[48:51]
    v_lshlrev_b32 v218, 16, v74
    v_and_b32 v219, s101, v74
    v_mfma_f32_16x16x32_bf16 v[52:55], a[76:79], a[104:107], v[52:55]
    v_lshlrev_b32 v222, 16, v75
    v_and_b32 v223, s101, v75
    v_mfma_f32_16x16x32_bf16 v[56:59], a[76:79], a[108:111], v[56:59]
    s_waitcnt vmcnt(12)
    v_fma_f32 v208, v210, v88, v89
    v_fma_f32 v209, v211, v88, v89
    v_mfma_f32_16x16x32_bf16 v[60:63], a[76:79], a[112:115], v[60:63]
    v_fma_f32 v212, v214, v88, v89
    v_fma_f32 v213, v215, v88, v89
    v_mfma_f32_16x16x32_bf16 v[48:51], a[80:83], a[96:99], v[48:51]
    v_fma_f32 v216, v218, v90, v91
    v_fma_f32 v217, v219, v90, v91
    v_mfma_f32_16x16x32_bf16 v[52:55], a[80:83], a[100:103], v[52:55]
    v_fma_f32 v220, v222, v90, v91
    v_fma_f32 v221, v223, v90, v91
    v_mfma_f32_16x16x32_bf16 v[56:59], a[80:83], a[104:107], v[56:59]
    s_waitcnt vmcnt(11)
    v_lshlrev_b32 v226, 16, v76
    v_and_b32 v227, s101, v76
    v_mfma_f32_16x16x32_bf16 v[60:63], a[80:83], a[108:111], v[60:63]
    v_lshlrev_b32 v230, 16, v77
    v_and_b32 v231, s101, v77
    v_mfma_f32_16x16x32_bf16 v[52:55], a[84:87], a[96:99], v[52:55]
    v_lshlrev_b32 v234, 16, v78
    v_and_b32 v235, s101, v78
    v_mfma_f32_16x16x32_bf16 v[56:59], a[84:87], a[100:103], v[56:59]
    v_lshlrev_b32 v238, 16, v79
    v_and_b32 v239, s101, v79
    v_mfma_f32_16x16x32_bf16 v[60:63], a[84:87], a[104:107], v[60:63]
    s_waitcnt vmcnt(10)
    v_fma_f32 v224, v226, v92, v93
    v_fma_f32 v225, v227, v92, v93
    v_mfma_f32_16x16x32_bf16 v[56:59], a[88:91], a[96:99], v[56:59]
    v_fma_f32 v228, v230, v92, v93
    v_fma_f32 v229, v231, v92, v93
    v_mfma_f32_16x16x32_bf16 v[60:63], a[88:91], a[100:103], v[60:63]
    v_fma_f32 v232, v234, v94, v95
    v_fma_f32 v233, v235, v94, v95
    v_mfma_f32_16x16x32_bf16 v[60:63], a[92:95], a[96:99], v[60:63]
    v_fma_f32 v236, v238, v94, v95
    v_fma_f32 v237, v239, v94, v95
    v_cvt_pk_bf16_f32 v96, v32, v33
    v_cvt_pk_bf16_f32 v97, v34, v35
    ds_write_b64 v23, v[96:97] offset:0
    v_cvt_pk_bf16_f32 v98, v36, v37
    v_cvt_pk_bf16_f32 v99, v38, v39
    ds_write_b64 v23, v[98:99] offset:512
    v_cvt_pk_bf16_f32 v100, v40, v41
    v_cvt_pk_bf16_f32 v101, v42, v43
    ds_write_b64 v23, v[100:101] offset:1024
    v_cvt_pk_bf16_f32 v102, v44, v45
    v_cvt_pk_bf16_f32 v103, v46, v47
    ds_write_b64 v23, v[102:103] offset:1536
    v_cvt_pk_bf16_f32 v104, v48, v49
    v_cvt_pk_bf16_f32 v105, v50, v51
    ds_write_b64 v23, v[104:105] offset:2048
    v_cvt_pk_bf16_f32 v106, v52, v53
    v_cvt_pk_bf16_f32 v107, v54, v55
    ds_write_b64 v23, v[106:107] offset:2560
    v_cvt_pk_bf16_f32 v108, v56, v57
    v_cvt_pk_bf16_f32 v109, v58, v59
    ds_write_b64 v23, v[108:109] offset:3072
    v_cvt_pk_bf16_f32 v110, v60, v61
    v_cvt_pk_bf16_f32 v111, v62, v63
    ds_write_b64 v23, v[110:111] offset:3584
    s_waitcnt lgkmcnt(0)
    s_barrier
    ds_read_b64_tr_b16 v[112:113], v24 offset:0
    ds_read_b64_tr_b16 v[114:115], v24 offset:32
    ds_read_b64_tr_b16 v[116:117], v24 offset:64
    ds_read_b64_tr_b16 v[118:119], v24 offset:96
    ds_read_b64_tr_b16 v[120:121], v24 offset:512
    ds_read_b64_tr_b16 v[122:123], v24 offset:544
    ds_read_b64_tr_b16 v[124:125], v24 offset:576
    ds_read_b64_tr_b16 v[126:127], v24 offset:608
    s_waitcnt lgkmcnt(7)
    v_lshlrev_b32 v128, 16, v112
    v_and_b32 v129, s101, v112
    v_lshlrev_b32 v130, 16, v113
    v_and_b32 v131, s101, v113
    s_waitcnt lgkmcnt(6)
    v_lshlrev_b32 v132, 16, v114
    v_and_b32 v133, s101, v114
    v_lshlrev_b32 v134, 16, v115
    v_and_b32 v135, s101, v115
    v_pk_fma_f32 v[176:177], v[128:129], v[176:177], v[178:179]
    v_pk_fma_f32 v[180:181], v[130:131], v[180:181], v[182:183]
    v_pk_fma_f32 v[184:185], v[132:133], v[184:185], v[186:187]
    v_pk_fma_f32 v[188:189], v[134:135], v[188:189], v[190:191]
    v_cvt_pk_bf16_f32 v152, v176, v177
    v_cvt_pk_bf16_f32 v153, v180, v181
    v_cvt_pk_bf16_f32 v154, v184, v185
    v_cvt_pk_bf16_f32 v155, v188, v189
    s_mov_b32 s7, 11059200
    buffer_store_dwordx4 v[152:155], v28, s[44:47], s7 offen sc1
    s_waitcnt lgkmcnt(5)
    v_lshlrev_b32 v128, 16, v116
    v_and_b32 v129, s101, v116
    v_lshlrev_b32 v130, 16, v117
    v_and_b32 v131, s101, v117
    s_waitcnt lgkmcnt(4)
    v_lshlrev_b32 v132, 16, v118
    v_and_b32 v133, s101, v118
    v_lshlrev_b32 v134, 16, v119
    v_and_b32 v135, s101, v119
    v_pk_fma_f32 v[192:193], v[128:129], v[192:193], v[194:195]
    v_pk_fma_f32 v[196:197], v[130:131], v[196:197], v[198:199]
    v_pk_fma_f32 v[200:201], v[132:133], v[200:201], v[202:203]
    v_pk_fma_f32 v[204:205], v[134:135], v[204:205], v[206:207]
    v_cvt_pk_bf16_f32 v156, v192, v193
    v_cvt_pk_bf16_f32 v157, v196, v197
    v_cvt_pk_bf16_f32 v158, v200, v201
    v_cvt_pk_bf16_f32 v159, v204, v205
    s_mov_b32 s7, 11096064
    buffer_store_dwordx4 v[156:159], v28, s[44:47], s7 offen sc1
    s_waitcnt lgkmcnt(3)
    v_lshlrev_b32 v128, 16, v120
    v_and_b32 v129, s101, v120
    v_lshlrev_b32 v130, 16, v121
    v_and_b32 v131, s101, v121
    s_waitcnt lgkmcnt(2)
    v_lshlrev_b32 v132, 16, v122
    v_and_b32 v133, s101, v122
    v_lshlrev_b32 v134, 16, v123
    v_and_b32 v135, s101, v123
    v_pk_fma_f32 v[208:209], v[128:129], v[208:209], v[210:211]
    v_pk_fma_f32 v[212:213], v[130:131], v[212:213], v[214:215]
    v_pk_fma_f32 v[216:217], v[132:133], v[216:217], v[218:219]
    v_pk_fma_f32 v[220:221], v[134:135], v[220:221], v[222:223]
    v_cvt_pk_bf16_f32 v160, v208, v209
    v_cvt_pk_bf16_f32 v161, v212, v213
    v_cvt_pk_bf16_f32 v162, v216, v217
    v_cvt_pk_bf16_f32 v163, v220, v221
    s_mov_b32 s7, 11354112
    buffer_store_dwordx4 v[160:163], v28, s[44:47], s7 offen sc1
    s_waitcnt lgkmcnt(1)
    v_lshlrev_b32 v128, 16, v124
    v_and_b32 v129, s101, v124
    v_lshlrev_b32 v130, 16, v125
    v_and_b32 v131, s101, v125
    s_waitcnt lgkmcnt(0)
    v_lshlrev_b32 v132, 16, v126
    v_and_b32 v133, s101, v126
    v_lshlrev_b32 v134, 16, v127
    v_and_b32 v135, s101, v127
    v_pk_fma_f32 v[224:225], v[128:129], v[224:225], v[226:227]
    v_pk_fma_f32 v[228:229], v[130:131], v[228:229], v[230:231]
    v_pk_fma_f32 v[232:233], v[132:133], v[232:233], v[234:235]
    v_pk_fma_f32 v[236:237], v[134:135], v[236:237], v[238:239]
    v_cvt_pk_bf16_f32 v164, v224, v225
    v_cvt_pk_bf16_f32 v165, v228, v229
    v_cvt_pk_bf16_f32 v166, v232, v233
    v_cvt_pk_bf16_f32 v167, v236, v237
    s_mov_b32 s7, 11390976
    buffer_store_dwordx4 v[164:167], v28, s[44:47], s7 offen sc1
    s_mul_i32 s8, s3, 144
    s_add_u32 s8, s8, s2
    s_lshl_b32 s8, s8, 7
    s_add_u32 s8, s8, 147456
    s_waitcnt vmcnt(0)
    s_mov_b32 exec_lo, 0xff
    s_mov_b32 exec_hi, 0x0
    buffer_store_dwordx4 v[2:5], v4, s[44:47], s8 offen sc1
    s_mov_b64 exec, -1
    s_lshl_b32 s8, s2, 2
    s_add_u32 s8, s8, s3
    s_and_b32 s7, s8, 0xffffffe3
    s_cmp_lg_u32 s7, 0
    s_cbranch_scc1 L_skip_8
    s_lshl_b32 s8, s2, 7
    s_add_u32 s8, s8, 221184
    s_mov_b32 exec_lo, 0xff
    s_mov_b32 exec_hi, 0x0
    buffer_store_dwordx4 v[2:5], v4, s[44:47], s8 offen sc1
    s_mov_b64 exec, -1
    s_nop 0
L_skip_8:
    s_mov_b32 s7, 13418496
    buffer_store_dwordx4 v[112:115], v22, s[44:47], s7 offen sc1
    s_mov_b32 s7, 13455360
    buffer_store_dwordx4 v[116:119], v22, s[44:47], s7 offen sc1
    s_mov_b32 s7, 13713408
    buffer_store_dwordx4 v[120:123], v22, s[44:47], s7 offen sc1
    s_mov_b32 s7, 13750272
    buffer_store_dwordx4 v[124:127], v22, s[44:47], s7 offen sc1
    s_barrier
    s_cmp_eq_u32 s95, 0
    s_cbranch_scc0 L_skip_9
    v_lshlrev_b32 v10, 11, v1
    s_lshl_b32 s5, s69, 7
    s_add_u32 s5, s5, 86016
    s_waitcnt vmcnt(4)
    s_mov_b64 exec, 7
    s_mov_b32 s42, 400000
L_poll_10:
    buffer_load_dword v11, v10, s[44:47], s5 offen offset:12 sc1
    s_waitcnt vmcnt(0)
    v_cmp_ne_u32 vcc, s4, v11
    s_nop 1
    s_cbranch_vccz L_polld_11
    s_mov_b64 exec, vcc
    s_sub_u32 s42, s42, 1
    s_cbranch_scc0 L_poll_10
L_polld_11:
    s_mov_b64 exec, -1
L_skip_9:
    s_cmp_ge_u32 s91, 129024
    s_cbranch_scc1 L_wdone_13
L_wrest_12:
    s_add_u32 s92, s97, s91
    s_mov_b32 m0, s91
    s_add_u32 s91, s91, 4096
    buffer_load_dwordx4 v4, s[44:47], s92 offen sc1 lds
    s_cmp_lt_u32 s91, 129024
    s_cbranch_scc1 L_wrest_12
L_wdone_13:
    s_branch L_main
L_role_q:
    s_waitcnt lgkmcnt(0)
    s_mov_b64 s[48:49], s[16:17]
    s_mov_b32 s50, 2359296
    s_mov_b32 s51, 0x20000
    s_mov_b64 s[52:53], s[34:35]
    s_mov_b32 s54, 663552
    s_mov_b32 s55, 0x20000
    s_sub_u32 s12, s2, 144
    s_mov_b64 s[44:45], s[40:41]
    s_mov_b64 s[64:65], s[36:37]
    buffer_load_dword v5, off, s[44:47], 0 offset:12 sc1
    s_lshr_b32 s5, s68, 2
    s_mul_i32 s5, s5, 144
    s_mul_i32 s6, s3, 36
    s_add_u32 s5, s5, s6
    s_lshl_b32 s5, s5, 7
    s_add_u32 s5, s5, 147456
    s_lshr_b32 s6, s71, 1
    s_lshl_b32 s6, s6, 11
    s_lshl_b32 s7, s3, 9
    s_add_u32 s6, s6, s7
    s_add_u32 s6, s6, 89600
    v_mov_b32 v196, s5
    v_mov_b32 v197, s6
    v_cmp_gt_u32 vcc, 36, v1
    s_nop 1
    v_cndmask_b32 v196, v197, v196, vcc
    v_lshl_add_u32 v196, v1, 7, v196
    v_accvgpr_write_b32 a224, v196
    v_and_b32 v193, 7, v2
    v_lshrrev_b32 v194, 3, v2
    s_and_b32 s8, s3, 1
    v_lshlrev_b32 v192, 7, v3
    v_lshl_add_u32 v192, v193, 4, v192
    v_mul_u32_u24 v195, 18432, v194
    v_add_u32 v195, v195, v192
    v_accvgpr_write_b32 a225, v195
    s_mov_b32 s43, 0
    s_mul_i32 s86, s72, 36864
    s_add_u32 s86, s86, 11059200
    v_and_b32 v188, 3, v1
    v_bfe_u32 v189, v1, 2, 2
    s_mul_i32 s5, s3, 8448
    s_add_u32 s5, s5, 129024
    v_mul_u32_u24 v186, 264, v2
    v_mad_u32_u24 v186, v3, 40, v186
    v_add_u32 v186, s5, v186
    v_accvgpr_write_b32 a200, v186
    v_and_b32 v186, 1, v3
    v_lshlrev_b32 v186, 4, v186
    v_lshl_add_u32 v186, v189, 2, v186
    v_and_b32 v187, 2, v3
    v_add_u32 v186, v186, v187
    v_mul_u32_u24 v190, 264, v186
    v_add_u32 v190, 129024, v190
    s_lshr_b32 s7, s3, 1
    s_mul_i32 s5, s7, 80
    v_lshrrev_b32 v186, 1, v188
    v_mad_u32_u24 v191, v186, 40, v190
    v_add_u32 v191, s5, v191
    v_and_b32 v186, 1, v188
    v_mad_u32_u24 v187, v186, 24, v191
    v_add_u32 v187, 0, v187
    v_accvgpr_write_b32 a201, v187
    v_mad_u32_u24 v187, v186, 24, v191
    v_add_u32 v187, 8, v187
    v_accvgpr_write_b32 a202, v187
    v_mad_u32_u24 v187, v186, 16, v191
    v_add_u32 v187, 16, v187
    v_accvgpr_write_b32 a203, v187
    s_mul_i32 s5, s3, 24
    s_add_u32 s5, s5, 160
    v_min_u32 v186, 2, v188
    v_lshl_add_u32 v186, v186, 3, v190
    v_add_u32 v186, s5, v186
    v_accvgpr_write_b32 a204, v186
    s_mul_i32 s5, s3, 960
    v_lshlrev_b32 v186, 6, v2
    v_lshl_add_u32 v186, v3, 4, v186
    v_add_u32 v186, s5, v186
    v_accvgpr_write_b32 a205, v186
    v_lshrrev_b32 v186, 1, v3
    v_lshl_add_u32 v186, v2, 1, v186
    v_lshlrev_b32 v186, 4, v186
    s_add_u32 s5, s5, 640
    v_add_u32 v186, s5, v186
    v_accvgpr_write_b32 a220, v186
    s_mul_i32 s5, s68, 15
    v_lshrrev_b32 v186, 4, v0
    v_min_u32 v187, 14, v186
    v_add_u32 v187, s5, v187
    v_lshlrev_b32 v187, 4, v187
    v_lshl_add_u32 v187, v2, 12, v187
    v_accvgpr_write_b32 a206, v187
    v_and_b32 v193, 7, v2
    v_lshrrev_b32 v194, 3, v2
    s_and_b32 s8, s3, 1
    s_mul_i32 s5, s73, 36864
    s_mul_i32 s6, s8, 18432
    s_add_u32 s5, s5, s6
    s_mul_i32 s6, s71, 2304
    s_add_u32 s5, s5, s6
    v_lshlrev_b32 v192, 7, v3
    v_lshl_add_u32 v192, v193, 4, v192
    v_add_u32 v192, s5, v192
    v_lshl_add_u32 v195, v194, 3, v192
    v_accvgpr_write_b32 a226, v195
    v_lshl_add_u32 v195, v194, 9, v192
    v_accvgpr_write_b32 a217, v195
    v_and_b32 v196, 3, v2
    v_lshlrev_b32 v195, 8, v3
    v_lshl_add_u32 v195, v196, 6, v195
    v_lshrrev_b32 v196, 2, v2
    v_lshl_add_u32 v195, v196, 4, v195
    v_accvgpr_write_b32 a222, v195
    s_lshl_b32 s5, s72, 10
    s_add_u32 s5, s5, 946176
    v_lshlrev_b32 v195, 9, v194
    v_lshl_add_u32 v195, v3, 6, v195
    v_lshl_add_u32 v195, v193, 2, v195
    v_add_u32 v195, s5, v195
    v_accvgpr_write_b32 a228, v195
    s_mov_b32 s87, 11059200
    s_lshl_b32 s15, s68, 11
    s_add_u32 s15, s15, 225280
    s_mov_b32 s80, 0x00100001
    s_mov_b32 s81, 0x10000100
    s_lshl_b32 s88, s69, 16
    s_add_u32 s88, s88, 1142784
    s_lshl_b32 s89, s69, 12
    s_add_u32 s89, s89, 1011712
    s_mov_b32 s90, 290816
    v_lshrrev_b32 v186, 4, v0
    s_lshl_b32 s5, s68, 8
    v_lshl_add_u32 v186, v186, 4, s5
    v_accvgpr_write_b32 a207, v186
    v_mul_u32_u24 v186, 4370, v0
    v_lshrrev_b32 v186, 16, v186
    v_add_lshl_u32 v186, v186, v0, 4
    v_accvgpr_write_b32 a221, v186
    s_movk_i32 s7, 240
    v_cmp_gt_u32 s[76:77], s7, v0
    v_mul_u32_u24 v192, 1093, v0
    v_lshrrev_b32 v192, 16, v192
    v_mul_u32_u24 v193, 60, v192
    v_sub_u32 v193, v0, v193
    v_cmp_le_u32 vcc, 40, v193
    v_lshrrev_b32 v194, 2, v193
    v_subrev_u32 v195, 40, v193
    v_lshrrev_b32 v195, 1, v195
    v_cndmask_b32 v194, v194, v195, vcc
    v_and_b32 v195, 3, v193
    v_mul_u32_u24 v195, 24, v195
    v_and_b32 v196, 1, v193
    v_mad_u32_u24 v196, v196, 48, 12
    v_cndmask_b32 v195, v195, v196, vcc
    v_and_b32 v196, 1, v192
    v_mad_u32_u24 v196, v196, 9, v194
    v_cmp_ne_u32 vcc, 18, v196
    s_nop 0
    s_and_b64 s[78:79], s[76:77], vcc
    v_cmp_eq_u32 vcc, 9, v194
    v_mov_b32 v197, 18
    s_nop 0
    v_cndmask_b32 v196, v196, v197, vcc
    v_lshrrev_b32 v192, 1, v192
    v_mad_u32_u24 v196, v192, 19, v196
    v_mul_u32_u24 v196, 96, v196
    v_add_u32 v196, v196, v195
    v_add_u32 v196, 86016, v196
    v_accvgpr_write_b32 a208, v196
    v_add_u32 v196, 12, v196
    v_mul_u32_u24 v197, 12, v0
    v_add_u32 v197, 86784, v197
    v_cndmask_b32 v196, v197, v196, s[76:77]
    v_accvgpr_write_b32 a223, v196
    v_cmp_gt_u32 vcc, 40, v193
    s_nop 0
    s_and_b64 s[74:75], s[78:79], vcc
    s_mov_b32 vcc_lo, 0xaaaaaaaa
    s_mov_b32 vcc_hi, 0xaaaaaaaa
    s_and_b64 s[74:75], s[74:75], vcc
    s_orn2_b64 s[74:75], s[74:75], s[76:77]
    v_lshrrev_b32 v192, 3, v2
    v_lshrrev_b32 v193, 1, v3
    v_cmp_eq_u32 vcc, v192, v193
    v_mul_u32_u24 v192, 1824, v192
    v_and_b32 v193, 1, v3
    v_mad_u32_u24 v192, v193, 48, v192
    v_add_u32 v192, 86016, v192
    v_bfe_u32 v193, v2, 2, 1
    v_and_b32 v194, 3, v2
    v_lshl_add_u32 v193, v193, 3, v194
    v_mov_b32 v197, 89664
    s_movk_i32 s5, 96
    v_add_u32 v195, 0, v193
    v_mad_u32_u24 v195, v195, s5, v192
    v_cndmask_b32 v195, v197, v195, vcc
    v_accvgpr_write_b32 a209, v195
    v_add_u32 v195, 4, v193
    v_mad_u32_u24 v195, v195, s5, v192
    v_cndmask_b32 v195, v197, v195, vcc
    v_accvgpr_write_b32 a210, v195
    v_lshlrev_b32 v195, 3, v194
    v_mov_b32 v198, 0x12111012
    v_lshrrev_b32 v195, v195, v198
    v_and_b32 v195, 0xff, v195
    v_mad_u32_u24 v195, v195, s5, v192
    v_cndmask_b32 v195, v197, v195, vcc
    v_accvgpr_write_b32 a211, v195
    s_mul_i32 s5, s72, 36864
    v_lshrrev_b32 v192, 3, v2
    v_mul_u32_u24 v192, 18432, v192
    v_and_b32 v193, 7, v2
    v_lshl_add_u32 v192, v193, 4, v192
    v_add_u32 v192, s5, v192
    s_lshl_b32 s5, s69, 10
    v_lshl_add_u32 v194, v3, 8, v192
    v_add_u32 v194, s5, v194
    v_accvgpr_write_b32 a212, v194
    s_lshl_b32 s5, s69, 7
    s_add_u32 s5, s5, 16384
    v_lshlrev_b32 v194, 3, v193
    v_sub_u32 v194, v192, v194
    v_lshrrev_b32 v195, 1, v3
    v_lshl_add_u32 v194, v195, 6, v194
    v_add_u32 v194, s5, v194
    v_accvgpr_write_b32 a213, v194
    v_and_b32 v193, 7, v2
    s_and_b32 s8, s3, 1
    s_mul_i32 s5, s73, 36864
    s_mul_i32 s6, s71, 4608
    s_add_u32 s5, s5, s6
    s_lshl_b32 s6, s8, 7
    s_add_u32 s5, s5, s6
    v_lshlrev_b32 v192, 8, v3
    v_lshl_add_u32 v192, v193, 4, v192
    v_add_u32 v192, s5, v192
    v_lshrrev_b32 v194, 3, v2
    v_lshl_add_u32 v195, v194, 3, v192
    v_accvgpr_write_b32 a214, v195
    s_lshl_b32 s5, s70, 13
    s_lshl_b32 s6, s3, 8
    s_add_u32 s5, s5, s6
    s_add_u32 s5, s5, 684032
    v_lshl_add_u32 v195, v2, 4, s5
    v_lshl_add_u32 v196, v3, 10, v195
    v_accvgpr_write_b32 a216, v196
    s_lshl_b32 s6, s71, 10
    v_add_u32 v195, s6, v195
    v_accvgpr_write_b32 a215, v195
    s_lshl_b32 s5, s73, 5
    s_lshl_b32 s6, s8, 3
    s_add_u32 s5, s5, s6
    s_mul_i32 s5, s5, 1152
    s_mul_i32 s6, s71, 144
    s_add_u32 s5, s5, s6
    v_lshl_add_u32 v195, v194, 4, v193
    v_mul_u32_u24 v195, 1152, v195
    v_and_b32 v196, 1, v3
    v_lshl_add_u32 v195, v196, 5, v195
    v_lshrrev_b32 v196, 1, v3
    v_lshl_add_u32 v195, v196, 4, v195
    v_add_u32 v195, s5, v195
    v_accvgpr_write_b32 a218, v195
    v_lshlrev_b32 v195, 7, v3
    v_lshl_add_u32 v195, v193, 4, v195
    v_add_u32 v195, 4096, v195
    v_accvgpr_write_b32 a219, v195
    s_lshl_b32 s5, s72, 4
    s_add_u32 s5, s5, s69
    s_lshl_b32 s5, s5, 7
    s_add_u32 s5, s5, 290816
    v_accvgpr_read_b32 v195, a215
    v_writelane_b32 v195, s5, 1
    s_add_u32 s5, s5, 131072
    v_writelane_b32 v195, s5, 2
    s_lshl_b32 s5, s73, 4
    s_lshl_b32 s6, s71, 1
    s_add_u32 s5, s5, s6
    s_and_b32 s6, s3, 1
    s_add_u32 s5, s5, s6
    s_lshl_b32 s5, s5, 7
    s_add_u32 s5, s5, 552960
    v_writelane_b32 v195, s5, 3
    s_lshl_b32 s5, s69, 7
    s_add_u32 s5, s5, s15
    v_writelane_b32 v195, s5, 4
    s_add_u32 s5, s5, 32768
    v_writelane_b32 v195, s5, 5
    s_lshl_b32 s5, s70, 2
    s_add_u32 s5, s5, s3
    s_lshl_b32 s5, s5, 3
    s_add_u32 s5, s5, s71
    s_lshl_b32 s5, s5, 6
    s_add_u32 s5, s5, 946176
    v_writelane_b32 v195, s5, 6
    v_accvgpr_write_b32 a227, v195
    v_lshl_add_u32 v195, v2, 2, s5
    v_accvgpr_write_b32 a229, v195
    s_waitcnt vmcnt(0)
    v_readfirstlane_b32 s4, v5
    s_nop 0
    s_mul_i32 s4, s4, 0x9e3779b1
    s_add_u32 s4, s4, 0x7f4a7c15
    s_or_b32 s4, s4, 1
    v_mov_b32 v5, s4
    s_getreg_b32 s100, hwreg(HW_REG_XCC_ID, 0, 4)
    s_cmp_lg_u32 s3, 0
    s_cbranch_scc1 L_skip_14
    s_lshl_b32 s5, s68, 4
    s_add_u32 s5, s5, s69
    s_lshl_b32 s5, s5, 7
    s_add_u32 s5, s5, 102400
    v_mov_b32 v186, s100
    v_mov_b32 v187, v5
    s_mov_b32 exec_lo, 0xff
    s_mov_b32 exec_hi, 0x0
    buffer_store_dwordx4 v[184:187], v4, s[44:47], s5 offen sc1
    s_mov_b64 exec, -1
    s_nop 0
L_skip_14:
    v_mov_b64 v[180:181], 0
    v_mov_b64 v[182:183], 0
    s_lshl_b32 s5, s72, 4
    s_add_u32 s5, s5, s69
    s_lshl_b32 s5, s5, 7
    s_add_u32 s5, s5, 290816
    s_add_u32 s6, s5, 131072
    s_lshl_b32 s7, s73, 4
    s_lshl_b32 s8, s71, 1
    s_add_u32 s7, s7, s8
    s_and_b32 s8, s3, 1
    s_add_u32 s7, s7, s8
    s_lshl_b32 s7, s7, 7
    s_add_u32 s7, s7, 552960
    s_mov_b32 exec_lo, 0xff
    s_mov_b32 exec_hi, 0x0
    buffer_store_dwordx4 v[180:183], v4, s[44:47], s5 offen sc1
    buffer_store_dwordx4 v[180:183], v4, s[44:47], s6 offen sc1
    buffer_store_dwordx4 v[180:183], v4, s[44:47], s7 offen sc1
    s_lshl_b32 s5, s69, 7
    s_add_u32 s5, s5, s15
    s_add_u32 s6, s5, 32768
    s_cmp_lg_u32 s3, 0
    s_cbranch_scc1 L_skip_15
    buffer_store_dwordx4 v[180:183], v4, s[44:47], s5 offen sc1
    buffer_store_dwordx4 v[180:183], v4, s[44:47], s6 offen sc1
    s_nop 1
L_skip_15:
    s_mov_b64 exec, -1
    v_accvgpr_read_b32 v184, a215
    v_accvgpr_read_b32 v185, a207
    s_lshl_b32 s5, s68, 12
    s_mul_i32 s6, s3, 960
    s_add_u32 s5, s5, s6
    s_add_u32 s5, s5, s88
    s_add_u32 s6, s5, 1048576
    s_add_u32 s7, s89, 65536
    s_mov_b32 exec_lo, 0xffffffff
    s_mov_b32 exec_hi, 0xfffffff
    buffer_store_dwordx4 v[180:183], v4, s[44:47], s5 offen sc1
    buffer_store_dwordx4 v[180:183], v4, s[44:47], s6 offen sc1
    s_mov_b32 exec_lo, 0x10001
    s_mov_b32 exec_hi, 0x10001
    buffer_store_dwordx4 v[180:183], v185, s[44:47], s89 offen sc1
    buffer_store_dwordx4 v[180:183], v185, s[44:47], s7 offen sc1
    s_mov_b32 exec_lo, 0xffff
    s_mov_b32 exec_hi, 0x0
    buffer_store_dwordx4 v[180:183], v184, s[44:47], 0 offen sc1
    v_accvgpr_read_b32 v184, a229
    buffer_store_dword v180, v184, s[44:47], 0 offen sc1
    s_mov_b64 exec, -1
    s_mul_i32 s5, s12, 36864
    s_mul_i32 s6, s3, 640
    v_add_u32 v8, s6, v1
    v_mul_u32_u24 v9, 3592, v8
    v_lshrrev_b32 v9, 18, v9
    v_sub_u32 v8, v8, v9
    v_lshlrev_b32 v8, 4, v8
    s_lshl_b32 s7, s6, 4
    s_add_u32 s7, s7, 16384
    s_mov_b32 m0, s7
    s_add_u32 s6, s6, 64
    buffer_load_dwordx4 v8, s[48:51], s5 offen lds
    v_add_u32 v8, s6, v1
    v_mul_u32_u24 v9, 3592, v8
    v_lshrrev_b32 v9, 18, v9
    v_sub_u32 v8, v8, v9
    v_lshlrev_b32 v8, 4, v8
    s_lshl_b32 s7, s6, 4
    s_add_u32 s7, s7, 16384
    s_mov_b32 m0, s7
    s_add_u32 s6, s6, 64
    buffer_load_dwordx4 v8, s[48:51], s5 offen lds
    v_add_u32 v8, s6, v1
    v_mul_u32_u24 v9, 3592, v8
    v_lshrrev_b32 v9, 18, v9
    v_sub_u32 v8, v8, v9
    v_lshlrev_b32 v8, 4, v8
    s_lshl_b32 s7, s6, 4
    s_add_u32 s7, s7, 16384
    s_mov_b32 m0, s7
    s_add_u32 s6, s6, 64
    buffer_load_dwordx4 v8, s[48:51], s5 offen lds
    v_add_u32 v8, s6, v1
    v_mul_u32_u24 v9, 3592, v8
    v_lshrrev_b32 v9, 18, v9
    v_sub_u32 v8, v8, v9
    v_lshlrev_b32 v8, 4, v8
    s_lshl_b32 s7, s6, 4
    s_add_u32 s7, s7, 16384
    s_mov_b32 m0, s7
    s_add_u32 s6, s6, 64
    buffer_load_dwordx4 v8, s[48:51], s5 offen lds
    v_add_u32 v8, s6, v1
    v_mul_u32_u24 v9, 3592, v8
    v_lshrrev_b32 v9, 18, v9
    v_sub_u32 v8, v8, v9
    v_lshlrev_b32 v8, 4, v8
    s_lshl_b32 s7, s6, 4
    s_add_u32 s7, s7, 16384
    s_mov_b32 m0, s7
    s_add_u32 s6, s6, 64
    buffer_load_dwordx4 v8, s[48:51], s5 offen lds
    v_add_u32 v8, s6, v1
    v_mul_u32_u24 v9, 3592, v8
    v_lshrrev_b32 v9, 18, v9
    v_sub_u32 v8, v8, v9
    v_lshlrev_b32 v8, 4, v8
    s_lshl_b32 s7, s6, 4
    s_add_u32 s7, s7, 16384
    s_mov_b32 m0, s7
    s_add_u32 s6, s6, 64
    buffer_load_dwordx4 v8, s[48:51], s5 offen lds
    v_add_u32 v8, s6, v1
    v_mul_u32_u24 v9, 3592, v8
    v_lshrrev_b32 v9, 18, v9
    v_sub_u32 v8, v8, v9
    v_lshlrev_b32 v8, 4, v8
    s_lshl_b32 s7, s6, 4
    s_add_u32 s7, s7, 16384
    s_mov_b32 m0, s7
    s_add_u32 s6, s6, 64
    buffer_load_dwordx4 v8, s[48:51], s5 offen lds
    v_add_u32 v8, s6, v1
    v_mul_u32_u24 v9, 3592, v8
    v_lshrrev_b32 v9, 18, v9
    v_sub_u32 v8, v8, v9
    v_lshlrev_b32 v8, 4, v8
    s_lshl_b32 s7, s6, 4
    s_add_u32 s7, s7, 16384
    s_mov_b32 m0, s7
    s_add_u32 s6, s6, 64
    buffer_load_dwordx4 v8, s[48:51], s5 offen lds
    v_add_u32 v8, s6, v1
    v_mul_u32_u24 v9, 3592, v8
    v_lshrrev_b32 v9, 18, v9
    v_sub_u32 v8, v8, v9
    v_lshlrev_b32 v8, 4, v8
    s_lshl_b32 s7, s6, 4
    s_add_u32 s7, s7, 16384
    s_mov_b32 m0, s7
    s_add_u32 s6, s6, 64
    buffer_load_dwordx4 v8, s[48:51], s5 offen lds
    v_add_u32 v8, s6, v1
    v_mul_u32_u24 v9, 3592, v8
    v_lshrrev_b32 v9, 18, v9
    v_sub_u32 v8, v8, v9
    v_lshlrev_b32 v8, 4, v8
    s_lshl_b32 s7, s6, 4
    s_add_u32 s7, s7, 16384
    s_mov_b32 m0, s7
    s_add_u32 s6, s6, 64
    buffer_load_dwordx4 v8, s[48:51], s5 offen lds
    s_and_b32 s10, s12, 15
    s_lshr_b32 s11, s12, 4
    s_mul_i32 s5, s10, 41472
    s_mul_i32 s6, s11, 288
    s_add_u32 s5, s5, s6
    s_mul_i32 s6, s3, 192
    v_add_u32 v8, s6, v1
    v_mul_u32_u24 v9, 3641, v8
    v_lshrrev_b32 v9, 16, v9
    v_mul_u32_u24 v9, 864, v9
    v_lshl_add_u32 v8, v8, 4, v9
    s_lshl_b32 s7, s6, 4
    s_add_u32 s7, s7, 0
    s_mov_b32 m0, s7
    s_nop 0
    buffer_load_dwordx4 v8, s[52:55], s5 offen lds
    v_add_u32 v8, s6, v1
    v_add_u32 v8, 64, v8
    v_mul_u32_u24 v9, 3641, v8
    v_lshrrev_b32 v9, 16, v9
    v_mul_u32_u24 v9, 864, v9
    v_lshl_add_u32 v8, v8, 4, v9
    s_lshl_b32 s7, s6, 4
    s_add_u32 s7, s7, 1024
    s_mov_b32 m0, s7
    s_nop 0
    buffer_load_dwordx4 v8, s[52:55], s5 offen lds
    v_add_u32 v8, s6, v1
    v_add_u32 v8, 128, v8
    v_mul_u32_u24 v9, 3641, v8
    v_lshrrev_b32 v9, 16, v9
    v_mul_u32_u24 v9, 864, v9
    v_lshl_add_u32 v8, v8, 4, v9
    s_lshl_b32 s7, s6, 4
    s_add_u32 s7, s7, 2048
    s_mov_b32 m0, s7
    s_nop 0
    buffer_load_dwordx4 v8, s[52:55], s5 offen lds
    s_lshl_b32 s5, s12, 7
    s_add_u32 s6, s5, 94208
    s_add_u32 s5, s5, 77824
    s_cmp_eq_u32 s3, 0
    s_cselect_b32 s5, s5, s6
    s_cmp_ge_u32 s3, 2
    s_cbranch_scc1 L_skip_16
    v_mov_b64 v[248:249], 0
    v_mov_b64 v[250:251], 0
    s_mov_b32 exec_lo, 0xff
    s_mov_b32 exec_hi, 0x0
    buffer_store_dwordx4 v[248:251], v4, s[44:47], s5 offen sc1
    s_mov_b64 exec, -1
    s_nop 0
L_skip_16:
    s_mul_i32 s5, s12, 36864
    s_lshl_b32 s6, s3, 11
    s_add_u32 s5, s5, s6
    v_lshlrev_b32 v6, 9, v3
    v_lshl_add_u32 v6, v2, 4, v6
    v_add_u32 v6, s5, v6
    s_cmp_lt_u32 s3, 2
    s_cselect_b32 s7, 0, 0x40000000
    s_cselect_b32 s9, -1, 0
    v_add_u32 v7, s7, v6
    s_lshl_b32 s6, s3, 6
    s_add_u32 s6, s6, 16384
    v_mul_u32_u24 v8, 1168, v2
    v_lshl_add_u32 v8, v3, 4, v8
    v_add_u32 v8, s6, v8
    v_mov_b64 v[56:57], 0
    v_mov_b64 v[58:59], 0
    s_waitcnt vmcnt(3)
    s_barrier
    ds_read_b128 v[16:19], v8 offset:0
    ds_read_b128 v[20:23], v8 offset:18688
    ds_read_b128 v[24:27], v8 offset:256
    ds_read_b128 v[28:31], v8 offset:18944
    ds_read_b128 v[32:35], v8 offset:512
    ds_read_b128 v[36:39], v8 offset:19200
    ds_read_b128 v[40:43], v8 offset:768
    ds_read_b128 v[44:47], v8 offset:19456
    ds_read_b128 v[48:51], v8 offset:1024
    ds_read_b128 v[52:55], v8 offset:19712
    s_mov_b32 s7, 0x3f803f80
    s_waitcnt lgkmcnt(8)
    v_swap_b32 v18, v20
    v_swap_b32 v19, v21
    s_mov_b32 s8, 8683520
    buffer_store_dwordx4 v[16:19], v6, s[44:47], s8 offen offset:0 sc1
    buffer_store_dwordx4 v[20:23], v6, s[44:47], s8 offen offset:256 sc1
    v_dot2c_f32_bf16 v56, s7, v16
    v_dot2c_f32_bf16 v57, v16, v16
    v_dot2c_f32_bf16 v56, s7, v17
    v_dot2c_f32_bf16 v57, v17, v17
    v_dot2c_f32_bf16 v58, s7, v18
    v_dot2c_f32_bf16 v59, v18, v18
    v_dot2c_f32_bf16 v58, s7, v19
    v_dot2c_f32_bf16 v59, v19, v19
    v_dot2c_f32_bf16 v56, s7, v20
    v_dot2c_f32_bf16 v57, v20, v20
    v_dot2c_f32_bf16 v56, s7, v21
    v_dot2c_f32_bf16 v57, v21, v21
    v_dot2c_f32_bf16 v58, s7, v22
    v_dot2c_f32_bf16 v59, v22, v22
    v_dot2c_f32_bf16 v58, s7, v23
    v_dot2c_f32_bf16 v59, v23, v23
    s_waitcnt lgkmcnt(6)
    v_swap_b32 v26, v28
    v_swap_b32 v27, v29
    s_mov_b32 s8, 8691712
    buffer_store_dwordx4 v[24:27], v6, s[44:47], s8 offen offset:0 sc1
    buffer_store_dwordx4 v[28:31], v6, s[44:47], s8 offen offset:256 sc1
    v_dot2c_f32_bf16 v56, s7, v24
    v_dot2c_f32_bf16 v57, v24, v24
    v_dot2c_f32_bf16 v56, s7, v25
    v_dot2c_f32_bf16 v57, v25, v25
    v_dot2c_f32_bf16 v58, s7, v26
    v_dot2c_f32_bf16 v59, v26, v26
    v_dot2c_f32_bf16 v58, s7, v27
    v_dot2c_f32_bf16 v59, v27, v27
    v_dot2c_f32_bf16 v56, s7, v28
    v_dot2c_f32_bf16 v57, v28, v28
    v_dot2c_f32_bf16 v56, s7, v29
    v_dot2c_f32_bf16 v57, v29, v29
    v_dot2c_f32_bf16 v58, s7, v30
    v_dot2c_f32_bf16 v59, v30, v30
    v_dot2c_f32_bf16 v58, s7, v31
    v_dot2c_f32_bf16 v59, v31, v31
    s_waitcnt lgkmcnt(4)
    v_swap_b32 v34, v36
    v_swap_b32 v35, v37
    s_mov_b32 s8, 8699904
    buffer_store_dwordx4 v[32:35], v6, s[44:47], s8 offen offset:0 sc1
    buffer_store_dwordx4 v[36:39], v6, s[44:47], s8 offen offset:256 sc1
    v_dot2c_f32_bf16 v56, s7, v32
    v_dot2c_f32_bf16 v57, v32, v32
    v_dot2c_f32_bf16 v56, s7, v33
    v_dot2c_f32_bf16 v57, v33, v33
    v_dot2c_f32_bf16 v58, s7, v34
    v_dot2c_f32_bf16 v59, v34, v34
    v_dot2c_f32_bf16 v58, s7, v35
    v_dot2c_f32_bf16 v59, v35, v35
    v_dot2c_f32_bf16 v56, s7, v36
    v_dot2c_f32_bf16 v57, v36, v36
    v_dot2c_f32_bf16 v56, s7, v37
    v_dot2c_f32_bf16 v57, v37, v37
    v_dot2c_f32_bf16 v58, s7, v38
    v_dot2c_f32_bf16 v59, v38, v38
    v_dot2c_f32_bf16 v58, s7, v39
    v_dot2c_f32_bf16 v59, v39, v39
    s_waitcnt lgkmcnt(2)
    v_swap_b32 v42, v44
    v_swap_b32 v43, v45
    s_mov_b32 s8, 8708096
    buffer_store_dwordx4 v[40:43], v6, s[44:47], s8 offen offset:0 sc1
    buffer_store_dwordx4 v[44:47], v6, s[44:47], s8 offen offset:256 sc1
    v_dot2c_f32_bf16 v56, s7, v40
    v_dot2c_f32_bf16 v57, v40, v40
    v_dot2c_f32_bf16 v56, s7, v41
    v_dot2c_f32_bf16 v57, v41, v41
    v_dot2c_f32_bf16 v58, s7, v42
    v_dot2c_f32_bf16 v59, v42, v42
    v_dot2c_f32_bf16 v58, s7, v43
    v_dot2c_f32_bf16 v59, v43, v43
    v_dot2c_f32_bf16 v56, s7, v44
    v_dot2c_f32_bf16 v57, v44, v44
    v_dot2c_f32_bf16 v56, s7, v45
    v_dot2c_f32_bf16 v57, v45, v45
    v_dot2c_f32_bf16 v58, s7, v46
    v_dot2c_f32_bf16 v59, v46, v46
    v_dot2c_f32_bf16 v58, s7, v47
    v_dot2c_f32_bf16 v59, v47, v47
    s_waitcnt lgkmcnt(1)
    v_and_b32 v48, s9, v48
    v_and_b32 v49, s9, v49
    v_and_b32 v50, s9, v50
    v_and_b32 v51, s9, v51
    s_waitcnt lgkmcnt(0)
    v_and_b32 v52, s9, v52
    v_and_b32 v53, s9, v53
    v_and_b32 v54, s9, v54
    v_and_b32 v55, s9, v55
    v_swap_b32 v50, v52
    v_swap_b32 v51, v53
    s_mov_b32 s8, 8716288
    buffer_store_dwordx4 v[48:51], v7, s[44:47], s8 offen offset:0 sc1
    buffer_store_dwordx4 v[52:55], v7, s[44:47], s8 offen offset:256 sc1
    v_dot2c_f32_bf16 v56, s7, v48
    v_dot2c_f32_bf16 v57, v48, v48
    v_dot2c_f32_bf16 v56, s7, v49
    v_dot2c_f32_bf16 v57, v49, v49
    v_dot2c_f32_bf16 v58, s7, v50
    v_dot2c_f32_bf16 v59, v50, v50
    v_dot2c_f32_bf16 v58, s7, v51
    v_dot2c_f32_bf16 v59, v51, v51
    v_dot2c_f32_bf16 v56, s7, v52
    v_dot2c_f32_bf16 v57, v52, v52
    v_dot2c_f32_bf16 v56, s7, v53
    v_dot2c_f32_bf16 v57, v53, v53
    v_dot2c_f32_bf16 v58, s7, v54
    v_dot2c_f32_bf16 v59, v54, v54
    v_dot2c_f32_bf16 v58, s7, v55
    v_dot2c_f32_bf16 v59, v55, v55
    s_nop 2
    v_permlane16_swap_b32 v56, v57
    v_add_f32 v56, v56, v57
    v_mov_b32 v57, v56
    s_nop 1
    v_permlane32_swap_b32 v56, v57
    v_add_f32 v56, v56, v57
    v_mov_b32 v57, v56
    s_nop 1
    v_permlane16_swap_b32 v56, v57
    v_permlane16_swap_b32 v58, v59
    v_add_f32 v58, v58, v59
    v_mov_b32 v59, v58
    s_nop 1
    v_permlane32_swap_b32 v58, v59
    v_add_f32 v58, v58, v59
    v_mov_b32 v59, v58
    s_nop 1
    v_permlane16_swap_b32 v58, v59
    s_lshl_b32 s7, s3, 8
    v_lshl_add_u32 v8, v2, 4, s7
    ds_write_b128 v8, v[56:59] offset:13312
    s_waitcnt lgkmcnt(0)
    s_barrier
    s_cmp_lg_u32 s3, 0
    s_cbranch_scc1 L_skip_17
    v_lshlrev_b32 v8, 4, v2
    ds_read_b128 v[60:63], v8 offset:13312
    ds_read_b128 v[64:67], v8 offset:13568
    ds_read_b128 v[68:71], v8 offset:13824
    ds_read_b128 v[72:75], v8 offset:14080
    s_waitcnt lgkmcnt(2)
    v_pk_add_f32 v[60:61], v[60:61], v[64:65]
    s_waitcnt lgkmcnt(0)
    v_pk_add_f32 v[68:69], v[68:69], v[72:73]
    v_pk_add_f32 v[60:61], v[60:61], v[68:69]
    v_pk_add_f32 v[62:63], v[62:63], v[66:67]
    v_pk_add_f32 v[70:71], v[70:71], v[74:75]
    v_pk_add_f32 v[62:63], v[62:63], v[70:71]
    v_mul_f32 v60, 0x3ae38e39, v60
    v_mul_f32 v61, 0x3ae38e39, v61
    v_fma_f32 v61, -v60, v60, v61
    v_max_f32 v61, 0, v61
    v_add_f32 v61, 0x3727c5ac, v61
    v_rsq_f32 v76, v61
    s_nop 0
    v_mul_f32 v77, v60, v76
    v_sub_f32 v77, 0, v77
    v_mul_f32 v62, 0x3ae38e39, v62
    v_mul_f32 v63, 0x3ae38e39, v63
    v_fma_f32 v63, -v62, v62, v63
    v_max_f32 v63, 0, v63
    v_add_f32 v63, 0x3727c5ac, v63
    v_rsq_f32 v78, v63
    s_nop 0
    v_mul_f32 v79, v62, v78
    v_sub_f32 v79, 0, v79
    s_lshl_b32 s7, s12, 8
    s_add_u32 s7, s7, 11042816
    s_mov_b32 exec_lo, 0xffff
    s_mov_b32 exec_hi, 0x0
    buffer_store_dwordx4 v[76:79], v4, s[44:47], s7 offen sc1
    s_mov_b64 exec, -1
    s_nop 0
L_skip_17:
    s_lshl_b32 s8, s12, 7
    s_add_u32 s8, s8, 77824
    s_waitcnt vmcnt(0) lgkmcnt(0)
    s_barrier
    s_cmp_lg_u32 s3, 0
    s_cbranch_scc1 L_skip_18
    s_mov_b32 exec_lo, 0xff
    s_mov_b32 exec_hi, 0x0
    buffer_store_dwordx4 v[2:5], v4, s[44:47], s8 offen sc1
    s_mov_b64 exec, -1
    s_nop 0
L_skip_18:
    v_lshrrev_b32 v12, 1, v3
    v_mul_u32_u24 v12, 2, v12
    v_lshl_add_u32 v12, v3, 3, v12
    v_bfe_u32 v13, v1, 2, 2
    v_add_u32 v12, v12, v13
    v_mul_u32_u24 v12, 288, v12
    v_and_b32 v14, 3, v1
    v_lshl_add_u32 v12, v14, 3, v12
    v_lshrrev_b32 v15, 1, v13
    v_mul_u32_u24 v15, 16, v15
    v_add_u32 v15, v15, v13
    v_add_u32 v15, 16, v15
    v_mul_u32_u24 v15, 288, v15
    v_lshl_add_u32 v15, v14, 3, v15
    v_and_b32 v16, 7, v2
    v_lshlrev_b32 v16, 4, v16
    v_lshl_add_u32 v17, v3, 7, v16
    s_mul_i32 s5, s11, 165888
    s_add_u32 s5, s5, 5361664
    s_mul_i32 s6, s10, 4608
    s_add_u32 s6, s6, s5
    s_lshr_b32 s7, s10, 3
    s_add_u32 s7, s7, 16
    s_mul_i32 s7, s7, 4608
    s_add_u32 s5, s5, s7
    s_and_b32 s7, s10, 1
    s_lshl_b32 s7, s7, 3
    s_add_u32 s5, s5, s7
    s_bfe_u32 s9, s10, 0x20001
    s_cmp_lg_u32 s3, 0
    s_cbranch_scc1 L_skip_20
    ds_read_b64_tr_b16 v[20:21], v12 offset:0
    ds_read_b64_tr_b16 v[22:23], v12 offset:1152
    ds_read_b64_tr_b16 v[24:25], v15 offset:0
    s_add_u32 s7, s6, 0
    s_lshl_b32 s8, s9, 8
    s_add_u32 s8, s8, s5
    s_add_u32 s8, s8, 0
    v_lshlrev_b32 v18, 4, v2
    s_waitcnt lgkmcnt(0)
    buffer_store_dwordx4 v[20:23], v4, s[44:47], s7 offen sc1
    s_mov_b32 exec_lo, 0xffff
    s_mov_b32 exec_hi, 0x0
    buffer_store_dwordx2 v[24:25], v18, s[44:47], s8 offen sc1
    s_mov_b64 exec, -1
    s_nop 1
    ds_read_b64_tr_b16 v[20:21], v12 offset:128
    ds_read_b64_tr_b16 v[22:23], v12 offset:1280
    ds_read_b64_tr_b16 v[24:25], v15 offset:128
    s_add_u32 s7, s6, 4096
    s_lshl_b32 s8, s9, 7
    s_add_u32 s8, s8, s5
    s_add_u32 s8, s8, 4096
    v_lshlrev_b32 v18, 4, v2
    s_waitcnt lgkmcnt(0)
    s_mov_b32 exec_lo, 0xff00ff
    s_mov_b32 exec_hi, 0xff00ff
    buffer_store_dwordx4 v[20:23], v17, s[44:47], s7 offen sc1
    s_mov_b32 exec_lo, 0xff
    s_mov_b32 exec_hi, 0x0
    buffer_store_dwordx2 v[24:25], v18, s[44:47], s8 offen sc1
    s_mov_b64 exec, -1
    s_nop 1
    ds_read_b64_tr_b16 v[20:21], v12 offset:240
    ds_read_b64_tr_b16 v[22:23], v12 offset:1392
    ds_read_b64_tr_b16 v[24:25], v15 offset:240
    s_add_u32 s7, s6, 86016
    s_lshl_b32 s8, s9, 8
    s_add_u32 s8, s8, s5
    s_add_u32 s8, s8, 86016
    v_lshlrev_b32 v18, 4, v2
    s_waitcnt lgkmcnt(0)
    buffer_store_dwordx4 v[20:23], v4, s[44:47], s7 offen sc1
    s_mov_b32 exec_lo, 0xffff
    s_mov_b32 exec_hi, 0x0
    buffer_store_dwordx2 v[24:25], v18, s[44:47], s8 offen sc1
    s_mov_b64 exec, -1
    s_nop 1
L_skip_20:
    s_cmp_lg_u32 s3, 1
    s_cbranch_scc1 L_skip_22
    ds_read_b64_tr_b16 v[20:21], v12 offset:32
    ds_read_b64_tr_b16 v[22:23], v12 offset:1184
    ds_read_b64_tr_b16 v[24:25], v15 offset:32
    s_add_u32 s7, s6, 1024
    s_lshl_b32 s8, s9, 8
    s_add_u32 s8, s8, s5
    s_add_u32 s8, s8, 1024
    v_lshlrev_b32 v18, 4, v2
    s_waitcnt lgkmcnt(0)
    buffer_store_dwordx4 v[20:23], v4, s[44:47], s7 offen sc1
    s_mov_b32 exec_lo, 0xffff
    s_mov_b32 exec_hi, 0x0
    buffer_store_dwordx2 v[24:25], v18, s[44:47], s8 offen sc1
    s_mov_b64 exec, -1
    s_nop 1
    ds_read_b64_tr_b16 v[20:21], v12 offset:144
    ds_read_b64_tr_b16 v[22:23], v12 offset:1296
    ds_read_b64_tr_b16 v[24:25], v15 offset:144
    s_add_u32 s7, s6, 82944
    s_lshl_b32 s8, s9, 8
    s_add_u32 s8, s8, s5
    s_add_u32 s8, s8, 82944
    v_lshlrev_b32 v18, 4, v2
    s_waitcnt lgkmcnt(0)
    buffer_store_dwordx4 v[20:23], v4, s[44:47], s7 offen sc1
    s_mov_b32 exec_lo, 0xffff
    s_mov_b32 exec_hi, 0x0
    buffer_store_dwordx2 v[24:25], v18, s[44:47], s8 offen sc1
    s_mov_b64 exec, -1
    s_nop 1
    ds_read_b64_tr_b16 v[20:21], v12 offset:272
    ds_read_b64_tr_b16 v[22:23], v12 offset:1424
    ds_read_b64_tr_b16 v[24:25], v15 offset:272
    s_add_u32 s7, s6, 87040
    s_lshl_b32 s8, s9, 7
    s_add_u32 s8, s8, s5
    s_add_u32 s8, s8, 87040
    v_lshlrev_b32 v18, 4, v2
    s_waitcnt lgkmcnt(0)
    s_mov_b32 exec_lo, 0xff00ff
    s_mov_b32 exec_hi, 0xff00ff
    buffer_store_dwordx4 v[20:23], v17, s[44:47], s7 offen sc1
    s_mov_b32 exec_lo, 0xff
    s_mov_b32 exec_hi, 0x0
    buffer_store_dwordx2 v[24:25], v18, s[44:47], s8 offen sc1
    s_mov_b64 exec, -1
    s_nop 1
L_skip_22:
    s_cmp_lg_u32 s3, 2
    s_cbranch_scc1 L_skip_24
    ds_read_b64_tr_b16 v[20:21], v12 offset:64
    ds_read_b64_tr_b16 v[22:23], v12 offset:1216
    ds_read_b64_tr_b16 v[24:25], v15 offset:64
    s_add_u32 s7, s6, 2048
    s_lshl_b32 s8, s9, 8
    s_add_u32 s8, s8, s5
    s_add_u32 s8, s8, 2048
    v_lshlrev_b32 v18, 4, v2
    s_waitcnt lgkmcnt(0)
    buffer_store_dwordx4 v[20:23], v4, s[44:47], s7 offen sc1
    s_mov_b32 exec_lo, 0xffff
    s_mov_b32 exec_hi, 0x0
    buffer_store_dwordx2 v[24:25], v18, s[44:47], s8 offen sc1
    s_mov_b64 exec, -1
    s_nop 1
    ds_read_b64_tr_b16 v[20:21], v12 offset:176
    ds_read_b64_tr_b16 v[22:23], v12 offset:1328
    ds_read_b64_tr_b16 v[24:25], v15 offset:176
    s_add_u32 s7, s6, 83968
    s_lshl_b32 s8, s9, 8
    s_add_u32 s8, s8, s5
    s_add_u32 s8, s8, 83968
    v_lshlrev_b32 v18, 4, v2
    s_waitcnt lgkmcnt(0)
    buffer_store_dwordx4 v[20:23], v4, s[44:47], s7 offen sc1
    s_mov_b32 exec_lo, 0xffff
    s_mov_b32 exec_hi, 0x0
    buffer_store_dwordx2 v[24:25], v18, s[44:47], s8 offen sc1
    s_mov_b64 exec, -1
    s_nop 1
L_skip_24:
    s_cmp_lg_u32 s3, 3
    s_cbranch_scc1 L_skip_26
    ds_read_b64_tr_b16 v[20:21], v12 offset:96
    ds_read_b64_tr_b16 v[22:23], v12 offset:1248
    ds_read_b64_tr_b16 v[24:25], v15 offset:96
    s_add_u32 s7, s6, 3072
    s_lshl_b32 s8, s9, 8
    s_add_u32 s8, s8, s5
    s_add_u32 s8, s8, 3072
    v_lshlrev_b32 v18, 4, v2
    s_waitcnt lgkmcnt(0)
    buffer_store_dwordx4 v[20:23], v4, s[44:47], s7 offen sc1
    s_mov_b32 exec_lo, 0xffff
    s_mov_b32 exec_hi, 0x0
    buffer_store_dwordx2 v[24:25], v18, s[44:47], s8 offen sc1
    s_mov_b64 exec, -1
    s_nop 1
    ds_read_b64_tr_b16 v[20:21], v12 offset:208
    ds_read_b64_tr_b16 v[22:23], v12 offset:1360
    ds_read_b64_tr_b16 v[24:25], v15 offset:208
    s_add_u32 s7, s6, 84992
    s_lshl_b32 s8, s9, 8
    s_add_u32 s8, s8, s5
    s_add_u32 s8, s8, 84992
    v_lshlrev_b32 v18, 4, v2
    s_waitcnt lgkmcnt(0)
    buffer_store_dwordx4 v[20:23], v4, s[44:47], s7 offen sc1
    s_mov_b32 exec_lo, 0xffff
    s_mov_b32 exec_hi, 0x0
    buffer_store_dwordx2 v[24:25], v18, s[44:47], s8 offen sc1
    s_mov_b64 exec, -1
    s_nop 1
L_skip_26:
    s_lshl_b32 s8, s12, 7
    s_add_u32 s8, s8, 94208
    s_waitcnt vmcnt(0) lgkmcnt(0)
    s_barrier
    s_cmp_lg_u32 s3, 0
    s_cbranch_scc1 L_skip_27
    s_mov_b32 exec_lo, 0xff
    s_mov_b32 exec_hi, 0x0
    buffer_store_dwordx4 v[2:5], v4, s[44:47], s8 offen sc1
    s_mov_b64 exec, -1
    s_nop 0
L_skip_27:
    s_branch L_nc3
L_role_w:
    s_waitcnt lgkmcnt(0)
    s_mov_b64 s[48:49], s[30:31]
    s_mov_b32 s50, 1990656
    s_mov_b32 s51, 0x20000
    s_mov_b64 s[52:53], s[32:33]
    s_mov_b32 s54, 20736
    s_mov_b32 s55, 0x20000
    s_sub_u32 s12, s2, 208
    s_and_b32 s11, s12, 15
    s_lshr_b32 s10, s12, 4
    s_add_u32 s5, s10, 1
    s_cmp_eq_u32 s10, 2
    s_cselect_b32 s5, 0, s5
    s_mul_i32 s5, s5, 1152
    s_mul_i32 s6, s11, 72
    s_add_u32 s5, s5, s6
    s_lshl_b32 s93, s3, 11
    s_add_u32 s93, s93, 2048
    s_mul_i32 s94, s3, 15360
    s_add_u32 s94, s94, 12288
    s_cmp_eq_u32 s10, 1
    s_cbranch_scc1 L_skip_28
    s_mul_i32 s7, s11, 1296
    s_mov_b32 m0, s93
    s_nop 0
    buffer_load_dwordx4 v4, s[52:55], s7 offen lds
    buffer_load_dwordx4 v4, s[52:55], s7 offen offset:1024 lds
L_skip_28:
    v_add_u32 v8, 0, v1
    v_mul_u32_u24 v9, 43691, v8
    v_lshrrev_b32 v10, 17, v9
    v_lshrrev_b32 v9, 18, v9
    v_mul_u32_u24 v9, 3384, v9
    v_lshl_add_u32 v8, v8, 4, v9
    v_mul_u32_u24 v10, 12, v10
    v_sub_u32 v13, v8, v10
    v_add_u32 v8, 64, v1
    v_mul_u32_u24 v9, 43691, v8
    v_lshrrev_b32 v10, 17, v9
    v_lshrrev_b32 v9, 18, v9
    v_mul_u32_u24 v9, 3384, v9
    v_lshl_add_u32 v8, v8, 4, v9
    v_mul_u32_u24 v10, 12, v10
    v_sub_u32 v14, v8, v10
    v_add_u32 v8, 128, v1
    v_mul_u32_u24 v9, 43691, v8
    v_lshrrev_b32 v10, 17, v9
    v_lshrrev_b32 v9, 18, v9
    v_mul_u32_u24 v9, 3384, v9
    v_lshl_add_u32 v8, v8, 4, v9
    v_mul_u32_u24 v10, 12, v10
    v_sub_u32 v15, v8, v10
    s_mul_i32 s6, s3, 110592
    s_add_u32 s5, s5, s6
    s_mov_b32 s7, s94
    s_mov_b32 m0, s7
    s_add_u32 s7, s7, 1024
    buffer_load_dwordx4 v13, s[48:51], s5 offen lds
    s_mov_b32 m0, s7
    s_add_u32 s7, s7, 1024
    buffer_load_dwordx4 v14, s[48:51], s5 offen lds
    s_mov_b32 m0, s7
    s_add_u32 s7, s7, 1024
    buffer_load_dwordx4 v15, s[48:51], s5 offen lds
    s_add_u32 s5, s5, 442368
    s_mov_b32 m0, s7
    s_add_u32 s7, s7, 1024
    buffer_load_dwordx4 v13, s[48:51], s5 offen lds
    s_mov_b32 m0, s7
    s_add_u32 s7, s7, 1024
    buffer_load_dwordx4 v14, s[48:51], s5 offen lds
    s_mov_b32 m0, s7
    s_add_u32 s7, s7, 1024
    buffer_load_dwordx4 v15, s[48:51], s5 offen lds
    s_add_u32 s5, s5, 442368
    s_mov_b32 m0, s7
    s_add_u32 s7, s7, 1024
    buffer_load_dwordx4 v13, s[48:51], s5 offen lds
    s_mov_b32 m0, s7
    s_add_u32 s7, s7, 1024
    buffer_load_dwordx4 v14, s[48:51], s5 offen lds
    s_mov_b32 m0, s7
    s_add_u32 s7, s7, 1024
    buffer_load_dwordx4 v15, s[48:51], s5 offen lds
    s_add_u32 s5, s5, 442368
    s_mov_b32 m0, s7
    s_add_u32 s7, s7, 1024
    buffer_load_dwordx4 v13, s[48:51], s5 offen lds
    s_mov_b32 m0, s7
    s_add_u32 s7, s7, 1024
    buffer_load_dwordx4 v14, s[48:51], s5 offen lds
    s_mov_b32 m0, s7
    s_add_u32 s7, s7, 1024
    buffer_load_dwordx4 v15, s[48:51], s5 offen lds
    s_add_u32 s5, s5, 442368
    s_mov_b32 m0, s7
    s_add_u32 s7, s7, 1024
    buffer_load_dwordx4 v13, s[48:51], s5 offen lds
    s_mov_b32 m0, s7
    s_add_u32 s7, s7, 1024
    buffer_load_dwordx4 v14, s[48:51], s5 offen lds
    s_mov_b32 m0, s7
    s_add_u32 s7, s7, 1024
    buffer_load_dwordx4 v15, s[48:51], s5 offen lds
    s_add_u32 s5, s5, 442368
    s_mov_b64 s[44:45], s[40:41]
    s_mov_b64 s[64:65], s[36:37]
    buffer_load_dword v5, off, s[44:47], 0 offset:12 sc1
    s_lshl_b32 s5, s12, 7
    s_add_u32 s5, s5, 86016
    s_cmp_lg_u32 s3, 0
    s_cbranch_scc1 L_skip_29
    v_mov_b64 v[252:253], 0
    v_mov_b64 v[254:255], 0
    s_mov_b32 exec_lo, 0xff
    s_mov_b32 exec_hi, 0x0
    buffer_store_dwordx4 v[252:255], v4, s[44:47], s5 offen sc1
    s_mov_b64 exec, -1
    s_nop 0
L_skip_29:
    s_cmp_lg_u32 s10, 1
    s_cbranch_scc1 L_skip_30
    v_mov_b64 v[16:17], 0
    v_mov_b64 v[18:19], 0
    v_add_u32 v8, s93, v4
    ds_write_b128 v8, v[16:19]
    ds_write_b128 v8, v[16:19] offset:1024
    v_mul_u32_u24 v8, 38, v1
    v_add_u32 v8, s93, v8
    v_mov_b32 v16, 0x3f80
    s_mov_b32 exec_lo, 0x3ffff
    s_mov_b32 exec_hi, 0x0
    ds_write_b16 v8, v16
    ds_write_b16 v8, v16 offset:648
    s_mov_b64 exec, -1
L_skip_30:
    v_min_u32 v8, 2, v3
    v_mul_u32_u24 v6, 96, v2
    v_lshl_add_u32 v6, v8, 4, v6
    v_add_u32 v6, s94, v6
    s_lshl_b32 s6, 1, s10
    s_sub_u32 s6, s6, 1
    v_and_b32 v9, 3, v2
    v_subrev_u32 v9, s6, v9
    v_bfe_u32 v10, v2, 2, 1
    v_lshrrev_b32 v11, 3, v2
    v_mul_u32_u24 v12, 648, v11
    v_mul_u32_u24 v8, 288, v3
    v_add3_u32 v12, v12, v8, s93
    v_mad_u32_u24 v12, v10, 18, v12
    v_lshl_add_u32 v12, v9, 1, v12
    v_add_u32 v8, 0, v9
    v_cmp_gt_u32 s[74:75], 9, v8
    v_add_u32 v8, 4, v9
    v_cmp_gt_u32 s[76:77], 9, v8
    v_add_u32 v8, 8, v9
    v_cmp_gt_u32 s[78:79], 9, v8
    v_mov_b64 v[132:133], 0
    v_mov_b64 v[134:135], 0
    v_mov_b64 v[136:137], 0
    v_mov_b64 v[138:139], 0
    v_mov_b64 v[140:141], 0
    v_mov_b64 v[142:143], 0
    v_mov_b64 v[144:145], 0
    v_mov_b64 v[146:147], 0
    v_mov_b64 v[148:149], 0
    v_mov_b64 v[150:151], 0
    v_mov_b64 v[152:153], 0
    v_mov_b64 v[154:155], 0
    s_mul_i32 s5, s11, 129024
    s_add_u32 s5, s5, 3293184
    s_lshl_b32 s15, s10, 1
    s_add_u32 s15, s15, 0
    s_lshl_b32 s6, s15, 10
    s_cmp_lt_u32 s15, 5
    s_cselect_b32 s9, 3072, 0
    s_cselect_b32 s15, 0, 87040
    s_add_u32 s9, s9, 2048
    s_add_u32 s6, s6, s15
    s_add_u32 s6, s6, s5
    s_mul_i32 s15, s9, s3
    s_add_u32 s6, s6, s15
    s_lshl_b32 s9, s9, 2
    s_lshl_b32 s15, s10, 1
    s_add_u32 s15, s15, 1
    s_lshl_b32 s7, s15, 10
    s_cmp_lt_u32 s15, 5
    s_cselect_b32 s13, 3072, 0
    s_cselect_b32 s15, 0, 87040
    s_add_u32 s13, s13, 2048
    s_add_u32 s7, s7, s15
    s_add_u32 s7, s7, s5
    s_mul_i32 s15, s13, s3
    s_add_u32 s7, s7, s15
    s_lshl_b32 s13, s13, 2
    s_lshl_b32 s15, s10, 1
    s_add_u32 s15, s15, 2
    s_lshl_b32 s8, s15, 10
    s_cmp_lt_u32 s15, 5
    s_cselect_b32 s14, 3072, 0
    s_cselect_b32 s15, 0, 87040
    s_add_u32 s14, s14, 2048
    s_add_u32 s8, s8, s15
    s_add_u32 s8, s8, s5
    s_mul_i32 s15, s14, s3
    s_add_u32 s8, s8, s15
    s_lshl_b32 s14, s14, 2
    v_and_b32 v8, 3, v2
    v_lshlrev_b32 v7, 8, v3
    v_lshl_add_u32 v7, v8, 6, v7
    v_lshrrev_b32 v8, 2, v2
    v_lshl_add_u32 v7, v8, 4, v7
    s_waitcnt vmcnt(16)
    s_mov_b32 s82, 0xffffffff
    s_mov_b32 s83, 0xffff
    s_and_b64 exec, s[82:83], s[74:75]
    ds_read_u16 v132, v12 offset:0
    ds_read_u16 v133, v12 offset:36
    s_mov_b32 s82, 0xffffffff
    s_mov_b32 s83, 0x0
    s_and_b64 exec, s[82:83], s[74:75]
    ds_read_u16 v134, v12 offset:72
    ds_read_u16 v135, v12 offset:108
    ds_read_u16 v136, v12 offset:144
    ds_read_u16 v137, v12 offset:180
    ds_read_u16 v138, v12 offset:216
    ds_read_u16 v139, v12 offset:252
    s_mov_b32 s82, 0xffffffff
    s_mov_b32 s83, 0xffff
    s_and_b64 exec, s[82:83], s[76:77]
    ds_read_u16 v140, v12 offset:8
    ds_read_u16 v141, v12 offset:44
    s_mov_b32 s82, 0xffffffff
    s_mov_b32 s83, 0x0
    s_and_b64 exec, s[82:83], s[76:77]
    ds_read_u16 v142, v12 offset:80
    ds_read_u16 v143, v12 offset:116
    ds_read_u16 v144, v12 offset:152
    ds_read_u16 v145, v12 offset:188
    ds_read_u16 v146, v12 offset:224
    ds_read_u16 v147, v12 offset:260
    s_mov_b32 s82, 0xffffffff
    s_mov_b32 s83, 0xffff
    s_and_b64 exec, s[82:83], s[78:79]
    ds_read_u16 v148, v12 offset:16
    ds_read_u16 v149, v12 offset:52
    s_mov_b32 s82, 0xffffffff
    s_mov_b32 s83, 0x0
    s_and_b64 exec, s[82:83], s[78:79]
    ds_read_u16 v150, v12 offset:88
    ds_read_u16 v151, v12 offset:124
    ds_read_u16 v152, v12 offset:160
    ds_read_u16 v153, v12 offset:196
    ds_read_u16 v154, v12 offset:232
    ds_read_u16 v155, v12 offset:268
    s_mov_b64 exec, -1
    v_cmp_eq_u32 vcc, 0, v11
    s_waitcnt lgkmcnt(15)
    v_lshl_or_b32 v96, v133, 16, v132
    s_waitcnt lgkmcnt(15)
    v_lshl_or_b32 v97, v135, 16, v134
    s_waitcnt lgkmcnt(15)
    v_lshl_or_b32 v98, v137, 16, v136
    s_waitcnt lgkmcnt(15)
    v_lshl_or_b32 v99, v139, 16, v138
    v_cndmask_b32 v108, 0, v96, vcc
    v_cndmask_b32 v109, 0, v97, vcc
    v_cndmask_b32 v110, 0, v98, vcc
    v_cndmask_b32 v111, 0, v99, vcc
    v_sub_u32 v112, v96, v108
    v_sub_u32 v113, v97, v109
    v_sub_u32 v114, v98, v110
    v_sub_u32 v115, v99, v111
    s_waitcnt lgkmcnt(14)
    v_lshl_or_b32 v96, v141, 16, v140
    s_waitcnt lgkmcnt(12)
    v_lshl_or_b32 v97, v143, 16, v142
    s_waitcnt lgkmcnt(10)
    v_lshl_or_b32 v98, v145, 16, v144
    s_waitcnt lgkmcnt(8)
    v_lshl_or_b32 v99, v147, 16, v146
    v_cndmask_b32 v116, 0, v96, vcc
    v_cndmask_b32 v117, 0, v97, vcc
    v_cndmask_b32 v118, 0, v98, vcc
    v_cndmask_b32 v119, 0, v99, vcc
    v_sub_u32 v120, v96, v116
    v_sub_u32 v121, v97, v117
    v_sub_u32 v122, v98, v118
    v_sub_u32 v123, v99, v119
    s_waitcnt lgkmcnt(6)
    v_lshl_or_b32 v96, v149, 16, v148
    s_waitcnt lgkmcnt(4)
    v_lshl_or_b32 v97, v151, 16, v150
    s_waitcnt lgkmcnt(2)
    v_lshl_or_b32 v98, v153, 16, v152
    s_waitcnt lgkmcnt(0)
    v_lshl_or_b32 v99, v155, 16, v154
    v_cndmask_b32 v124, 0, v96, vcc
    v_cndmask_b32 v125, 0, v97, vcc
    v_cndmask_b32 v126, 0, v98, vcc
    v_cndmask_b32 v127, 0, v99, vcc
    v_sub_u32 v128, v96, v124
    v_sub_u32 v129, v97, v125
    v_sub_u32 v130, v98, v126
    v_sub_u32 v131, v99, v127
    s_waitcnt vmcnt(13)
    ds_read_b128 v[16:19], v6 offset:0
    ds_read_b128 v[20:23], v6 offset:48
    ds_read_b128 v[24:27], v6 offset:1536
    ds_read_b128 v[28:31], v6 offset:1584
    s_waitcnt lgkmcnt(3)
    v_mfma_f32_16x16x32_bf16 v[132:135], v[16:19], v[108:111], 0
    v_mfma_f32_16x16x32_bf16 v[136:139], v[16:19], v[116:119], 0
    v_mfma_f32_16x16x32_bf16 v[140:143], v[16:19], v[124:127], 0
    s_waitcnt lgkmcnt(2)
    v_mfma_f32_16x16x32_bf16 v[132:135], v[20:23], v[112:115], v[132:135]
    v_mfma_f32_16x16x32_bf16 v[136:139], v[20:23], v[120:123], v[136:139]
    v_mfma_f32_16x16x32_bf16 v[140:143], v[20:23], v[128:131], v[140:143]
    s_waitcnt lgkmcnt(1)
    v_mfma_f32_16x16x32_bf16 v[144:147], v[24:27], v[108:111], 0
    v_mfma_f32_16x16x32_bf16 v[148:151], v[24:27], v[116:119], 0
    v_mfma_f32_16x16x32_bf16 v[152:155], v[24:27], v[124:127], 0
    s_waitcnt lgkmcnt(0)
    v_mfma_f32_16x16x32_bf16 v[144:147], v[28:31], v[112:115], v[144:147]
    v_mfma_f32_16x16x32_bf16 v[148:151], v[28:31], v[120:123], v[148:151]
    v_mfma_f32_16x16x32_bf16 v[152:155], v[28:31], v[128:131], v[152:155]
    s_waitcnt vmcnt(10)
    ds_read_b128 v[32:35], v6 offset:3072
    ds_read_b128 v[36:39], v6 offset:3120
    ds_read_b128 v[40:43], v6 offset:4608
    ds_read_b128 v[44:47], v6 offset:4656
    s_waitcnt lgkmcnt(3)
    v_mfma_f32_16x16x32_bf16 v[156:159], v[32:35], v[108:111], 0
    v_mov_b32 v96, v132
    v_mov_b32 v97, v133
    v_mfma_f32_16x16x32_bf16 v[160:163], v[32:35], v[116:119], 0
    v_mov_b32 v98, v136
    v_mov_b32 v99, v137
    v_mfma_f32_16x16x32_bf16 v[164:167], v[32:35], v[124:127], 0
    v_mov_b32 v100, v140
    v_mov_b32 v101, v141
    s_waitcnt lgkmcnt(2)
    v_mfma_f32_16x16x32_bf16 v[156:159], v[36:39], v[112:115], v[156:159]
    v_add_f32 v96, v96, v134
    v_add_f32 v97, v97, v135
    v_mfma_f32_16x16x32_bf16 v[160:163], v[36:39], v[120:123], v[160:163]
    v_add_f32 v98, v98, v138
    v_add_f32 v99, v99, v139
    v_mfma_f32_16x16x32_bf16 v[164:167], v[36:39], v[128:131], v[164:167]
    v_add_f32 v100, v100, v142
    v_add_f32 v101, v101, v143
    s_waitcnt lgkmcnt(1)
    v_mfma_f32_16x16x32_bf16 v[168:171], v[40:43], v[108:111], 0
    v_add_f32 v96, v96, v144
    v_add_f32 v97, v97, v145
    v_mfma_f32_16x16x32_bf16 v[172:175], v[40:43], v[116:119], 0
    v_add_f32 v98, v98, v148
    v_add_f32 v99, v99, v149
    v_mfma_f32_16x16x32_bf16 v[176:179], v[40:43], v[124:127], 0
    v_add_f32 v100, v100, v152
    v_add_f32 v101, v101, v153
    s_waitcnt lgkmcnt(0)
    v_mfma_f32_16x16x32_bf16 v[168:171], v[44:47], v[112:115], v[168:171]
    v_add_f32 v96, v96, v146
    v_add_f32 v97, v97, v147
    v_mfma_f32_16x16x32_bf16 v[172:175], v[44:47], v[120:123], v[172:175]
    v_add_f32 v98, v98, v150
    v_add_f32 v99, v99, v151
    v_mfma_f32_16x16x32_bf16 v[176:179], v[44:47], v[128:131], v[176:179]
    v_add_f32 v100, v100, v154
    v_add_f32 v101, v101, v155
    s_waitcnt vmcnt(7)
    ds_read_b128 v[48:51], v6 offset:6144
    ds_read_b128 v[52:55], v6 offset:6192
    ds_read_b128 v[56:59], v6 offset:7680
    ds_read_b128 v[60:63], v6 offset:7728
    s_waitcnt lgkmcnt(3)
    v_mfma_f32_16x16x32_bf16 v[180:183], v[48:51], v[108:111], 0
    v_add_f32 v96, v96, v156
    v_add_f32 v97, v97, v157
    v_mfma_f32_16x16x32_bf16 v[184:187], v[48:51], v[116:119], 0
    v_add_f32 v98, v98, v160
    v_add_f32 v99, v99, v161
    v_mfma_f32_16x16x32_bf16 v[188:191], v[48:51], v[124:127], 0
    v_add_f32 v100, v100, v164
    v_add_f32 v101, v101, v165
    s_waitcnt lgkmcnt(2)
    v_mfma_f32_16x16x32_bf16 v[180:183], v[52:55], v[112:115], v[180:183]
    v_add_f32 v96, v96, v158
    v_add_f32 v97, v97, v159
    v_mfma_f32_16x16x32_bf16 v[184:187], v[52:55], v[120:123], v[184:187]
    v_add_f32 v98, v98, v162
    v_add_f32 v99, v99, v163
    v_mfma_f32_16x16x32_bf16 v[188:191], v[52:55], v[128:131], v[188:191]
    v_add_f32 v100, v100, v166
    v_add_f32 v101, v101, v167
    s_waitcnt lgkmcnt(1)
    v_mfma_f32_16x16x32_bf16 v[192:195], v[56:59], v[108:111], 0
    v_add_f32 v96, v96, v168
    v_add_f32 v97, v97, v169
    v_mfma_f32_16x16x32_bf16 v[196:199], v[56:59], v[116:119], 0
    v_add_f32 v98, v98, v172
    v_add_f32 v99, v99, v173
    v_mfma_f32_16x16x32_bf16 v[200:203], v[56:59], v[124:127], 0
    v_add_f32 v100, v100, v176
    v_add_f32 v101, v101, v177
    s_waitcnt lgkmcnt(0)
    v_mfma_f32_16x16x32_bf16 v[192:195], v[60:63], v[112:115], v[192:195]
    v_add_f32 v96, v96, v170
    v_add_f32 v97, v97, v171
    v_mfma_f32_16x16x32_bf16 v[196:199], v[60:63], v[120:123], v[196:199]
    v_add_f32 v98, v98, v174
    v_add_f32 v99, v99, v175
    v_mfma_f32_16x16x32_bf16 v[200:203], v[60:63], v[128:131], v[200:203]
    v_add_f32 v100, v100, v178
    v_add_f32 v101, v101, v179
    s_waitcnt vmcnt(4)
    ds_read_b128 v[64:67], v6 offset:9216
    ds_read_b128 v[68:71], v6 offset:9264
    ds_read_b128 v[72:75], v6 offset:10752
    ds_read_b128 v[76:79], v6 offset:10800
    s_waitcnt lgkmcnt(3)
    v_mfma_f32_16x16x32_bf16 v[204:207], v[64:67], v[108:111], 0
    v_add_f32 v96, v96, v180
    v_add_f32 v97, v97, v181
    v_mfma_f32_16x16x32_bf16 v[208:211], v[64:67], v[116:119], 0
    v_add_f32 v98, v98, v184
    v_add_f32 v99, v99, v185
    v_mfma_f32_16x16x32_bf16 v[212:215], v[64:67], v[124:127], 0
    v_add_f32 v100, v100, v188
    v_add_f32 v101, v101, v189
    s_waitcnt lgkmcnt(2)
    v_mfma_f32_16x16x32_bf16 v[204:207], v[68:71], v[112:115], v[204:207]
    v_add_f32 v96, v96, v182
    v_add_f32 v97, v97, v183
    v_mfma_f32_16x16x32_bf16 v[208:211], v[68:71], v[120:123], v[208:211]
    v_add_f32 v98, v98, v186
    v_add_f32 v99, v99, v187
    v_mfma_f32_16x16x32_bf16 v[212:215], v[68:71], v[128:131], v[212:215]
    v_add_f32 v100, v100, v190
    v_add_f32 v101, v101, v191
    s_waitcnt lgkmcnt(1)
    v_mfma_f32_16x16x32_bf16 v[216:219], v[72:75], v[108:111], 0
    v_add_f32 v96, v96, v192
    v_add_f32 v97, v97, v193
    v_mfma_f32_16x16x32_bf16 v[220:223], v[72:75], v[116:119], 0
    v_add_f32 v98, v98, v196
    v_add_f32 v99, v99, v197
    v_mfma_f32_16x16x32_bf16 v[224:227], v[72:75], v[124:127], 0
    v_add_f32 v100, v100, v200
    v_add_f32 v101, v101, v201
    s_waitcnt lgkmcnt(0)
    v_mfma_f32_16x16x32_bf16 v[216:219], v[76:79], v[112:115], v[216:219]
    v_add_f32 v96, v96, v194
    v_add_f32 v97, v97, v195
    v_mfma_f32_16x16x32_bf16 v[220:223], v[76:79], v[120:123], v[220:223]
    v_add_f32 v98, v98, v198
    v_add_f32 v99, v99, v199
    v_mfma_f32_16x16x32_bf16 v[224:227], v[76:79], v[128:131], v[224:227]
    v_add_f32 v100, v100, v202
    v_add_f32 v101, v101, v203
    s_waitcnt vmcnt(1)
    ds_read_b128 v[80:83], v6 offset:12288
    ds_read_b128 v[84:87], v6 offset:12336
    ds_read_b128 v[88:91], v6 offset:13824
    ds_read_b128 v[92:95], v6 offset:13872
    s_waitcnt lgkmcnt(3)
    v_mfma_f32_16x16x32_bf16 v[228:231], v[80:83], v[108:111], 0
    v_add_f32 v96, v96, v204
    v_add_f32 v97, v97, v205
    v_mfma_f32_16x16x32_bf16 v[232:235], v[80:83], v[116:119], 0
    v_add_f32 v98, v98, v208
    v_add_f32 v99, v99, v209
    v_mfma_f32_16x16x32_bf16 v[236:239], v[80:83], v[124:127], 0
    v_add_f32 v100, v100, v212
    v_add_f32 v101, v101, v213
    s_waitcnt lgkmcnt(2)
    v_mfma_f32_16x16x32_bf16 v[228:231], v[84:87], v[112:115], v[228:231]
    v_add_f32 v96, v96, v206
    v_add_f32 v97, v97, v207
    v_mfma_f32_16x16x32_bf16 v[232:235], v[84:87], v[120:123], v[232:235]
    v_add_f32 v98, v98, v210
    v_add_f32 v99, v99, v211
    v_mfma_f32_16x16x32_bf16 v[236:239], v[84:87], v[128:131], v[236:239]
    v_add_f32 v100, v100, v214
    v_add_f32 v101, v101, v215
    s_waitcnt lgkmcnt(1)
    v_mfma_f32_16x16x32_bf16 v[240:243], v[88:91], v[108:111], 0
    v_add_f32 v96, v96, v216
    v_add_f32 v97, v97, v217
    v_mfma_f32_16x16x32_bf16 v[244:247], v[88:91], v[116:119], 0
    v_add_f32 v98, v98, v220
    v_add_f32 v99, v99, v221
    v_mfma_f32_16x16x32_bf16 v[248:251], v[88:91], v[124:127], 0
    v_add_f32 v100, v100, v224
    v_add_f32 v101, v101, v225
    s_waitcnt lgkmcnt(0)
    v_mfma_f32_16x16x32_bf16 v[240:243], v[92:95], v[112:115], v[240:243]
    v_add_f32 v96, v96, v218
    v_add_f32 v97, v97, v219
    v_mfma_f32_16x16x32_bf16 v[244:247], v[92:95], v[120:123], v[244:247]
    v_add_f32 v98, v98, v222
    v_add_f32 v99, v99, v223
    v_mfma_f32_16x16x32_bf16 v[248:251], v[92:95], v[128:131], v[248:251]
    v_add_f32 v100, v100, v226
    v_add_f32 v101, v101, v227
    v_add_f32 v96, v96, v228
    v_add_f32 v97, v97, v229
    v_add_f32 v98, v98, v232
    v_add_f32 v99, v99, v233
    v_add_f32 v100, v100, v236
    v_add_f32 v101, v101, v237
    v_add_f32 v96, v96, v230
    v_add_f32 v97, v97, v231
    v_add_f32 v98, v98, v234
    v_add_f32 v99, v99, v235
    v_add_f32 v100, v100, v238
    v_add_f32 v101, v101, v239
    v_add_f32 v96, v96, v240
    v_add_f32 v97, v97, v241
    v_add_f32 v98, v98, v244
    v_add_f32 v99, v99, v245
    v_add_f32 v100, v100, v248
    v_add_f32 v101, v101, v249
    v_add_f32 v96, v96, v242
    v_add_f32 v97, v97, v243
    v_add_f32 v98, v98, v246
    v_add_f32 v99, v99, v247
    v_add_f32 v100, v100, v250
    v_add_f32 v101, v101, v251
    v_add_f32 v24, v96, v97
    v_add_f32 v25, v98, v99
    v_add_f32 v26, v100, v101
    v_mov_b32 v27, 0
    v_permlane16_swap_b32 v24, v25
    v_add_f32 v24, v24, v25
    v_mov_b32 v25, v24
    s_nop 1
    v_permlane32_swap_b32 v24, v25
    v_add_f32 v24, v24, v25
    v_mov_b32 v25, v24
    s_nop 1
    v_permlane16_swap_b32 v24, v25
    v_permlane16_swap_b32 v26, v27
    v_add_f32 v26, v26, v27
    v_mov_b32 v27, v26
    s_nop 1
    v_permlane32_swap_b32 v26, v27
    v_add_f32 v26, v26, v27
    v_mov_b32 v27, v26
    s_nop 1
    v_permlane16_swap_b32 v26, v27
    s_lshl_b32 s15, s3, 8
    v_lshl_add_u32 v8, v2, 4, s15
    ds_write_b128 v8, v[24:27]
    s_waitcnt vmcnt(0)
    v_readfirstlane_b32 s4, v5
    s_nop 0
    s_mul_i32 s4, s4, 0x9e3779b1
    s_add_u32 s4, s4, 0x7f4a7c15
    s_or_b32 s4, s4, 1
    v_mov_b32 v5, s4
    s_getreg_b32 s100, hwreg(HW_REG_XCC_ID, 0, 4)
    s_cmp_lg_u32 s3, 0
    s_cbranch_scc1 L_skip_31
    s_lshl_b32 s5, s68, 4
    s_add_u32 s5, s5, s69
    s_lshl_b32 s5, s5, 7
    s_add_u32 s5, s5, 102400
    v_mov_b32 v18, s100
    v_mov_b32 v19, v5
    s_mov_b32 exec_lo, 0xff
    s_mov_b32 exec_hi, 0x0
    buffer_store_dwordx4 v[16:19], v4, s[44:47], s5 offen sc1
    s_mov_b64 exec, -1
    s_nop 0
L_skip_31:
    s_cmp_eq_u32 s10, 1
    s_cselect_b32 s80, 0x44444444, 0
    s_mov_b32 s81, s80
    s_or_b64 s[78:79], s[78:79], s[80:81]
    v_lshlrev_b32 v8, 4, v2
    s_waitcnt lgkmcnt(0)
    s_barrier
    ds_read_b128 v[28:31], v8 offset:0
    ds_read_b128 v[32:35], v8 offset:256
    ds_read_b128 v[36:39], v8 offset:512
    ds_read_b128 v[40:43], v8 offset:768
    s_waitcnt lgkmcnt(2)
    v_pk_add_f32 v[28:29], v[28:29], v[32:33]
    s_waitcnt lgkmcnt(0)
    v_pk_add_f32 v[36:37], v[36:37], v[40:41]
    v_pk_add_f32 v[28:29], v[28:29], v[36:37]
    v_pk_add_f32 v[30:31], v[30:31], v[34:35]
    v_pk_add_f32 v[38:39], v[38:39], v[42:43]
    v_pk_add_f32 v[30:31], v[30:31], v[38:39]
    s_cmp_eq_u32 s10, 1
    s_cselect_b32 s15, 0, 0xbae38e39
    v_mul_f32 v44, s15, v28
    v_mul_f32 v46, s15, v29
    v_mul_f32 v48, s15, v30
    v_cndmask_b32 v48, v48, 1.0, s[80:81]
    v_pk_add_f32 v[132:133], v[132:133], v[44:45] op_sel_hi:[1,0]
    v_pk_add_f32 v[134:135], v[134:135], v[44:45] op_sel_hi:[1,0]
    v_cvt_pk_bf16_f32 v52, v132, v133
    v_cvt_pk_bf16_f32 v53, v134, v135
    v_pk_add_f32 v[144:145], v[144:145], v[44:45] op_sel_hi:[1,0]
    v_pk_add_f32 v[146:147], v[146:147], v[44:45] op_sel_hi:[1,0]
    v_cvt_pk_bf16_f32 v54, v144, v145
    v_cvt_pk_bf16_f32 v55, v146, v147
    s_mov_b64 exec, s[74:75]
    buffer_store_dwordx4 v[52:55], v7, s[44:47], s6 offen sc1
    s_mov_b64 exec, -1
    s_add_u32 s6, s6, s9
    v_pk_add_f32 v[136:137], v[136:137], v[46:47] op_sel_hi:[1,0]
    v_pk_add_f32 v[138:139], v[138:139], v[46:47] op_sel_hi:[1,0]
    v_cvt_pk_bf16_f32 v56, v136, v137
    v_cvt_pk_bf16_f32 v57, v138, v139
    v_pk_add_f32 v[148:149], v[148:149], v[46:47] op_sel_hi:[1,0]
    v_pk_add_f32 v[150:151], v[150:151], v[46:47] op_sel_hi:[1,0]
    v_cvt_pk_bf16_f32 v58, v148, v149
    v_cvt_pk_bf16_f32 v59, v150, v151
    s_mov_b64 exec, s[76:77]
    buffer_store_dwordx4 v[56:59], v7, s[44:47], s7 offen sc1
    s_mov_b64 exec, -1
    s_add_u32 s7, s7, s13
    v_pk_add_f32 v[140:141], v[140:141], v[48:49] op_sel_hi:[1,0]
    v_pk_add_f32 v[142:143], v[142:143], v[48:49] op_sel_hi:[1,0]
    v_cvt_pk_bf16_f32 v60, v140, v141
    v_cvt_pk_bf16_f32 v61, v142, v143
    v_pk_add_f32 v[152:153], v[152:153], v[48:49] op_sel_hi:[1,0]
    v_pk_add_f32 v[154:155], v[154:155], v[48:49] op_sel_hi:[1,0]
    v_cvt_pk_bf16_f32 v62, v152, v153
    v_cvt_pk_bf16_f32 v63, v154, v155
    s_mov_b64 exec, s[78:79]
    buffer_store_dwordx4 v[60:63], v7, s[44:47], s8 offen sc1
    s_mov_b64 exec, -1
    s_add_u32 s8, s8, s14
    v_pk_add_f32 v[156:157], v[156:157], v[44:45] op_sel_hi:[1,0]
    v_pk_add_f32 v[158:159], v[158:159], v[44:45] op_sel_hi:[1,0]
    v_cvt_pk_bf16_f32 v64, v156, v157
    v_cvt_pk_bf16_f32 v65, v158, v159
    v_pk_add_f32 v[168:169], v[168:169], v[44:45] op_sel_hi:[1,0]
    v_pk_add_f32 v[170:171], v[170:171], v[44:45] op_sel_hi:[1,0]
    v_cvt_pk_bf16_f32 v66, v168, v169
    v_cvt_pk_bf16_f32 v67, v170, v171
    s_mov_b64 exec, s[74:75]
    buffer_store_dwordx4 v[64:67], v7, s[44:47], s6 offen sc1
    s_mov_b64 exec, -1
    s_add_u32 s6, s6, s9
    v_pk_add_f32 v[160:161], v[160:161], v[46:47] op_sel_hi:[1,0]
    v_pk_add_f32 v[162:163], v[162:163], v[46:47] op_sel_hi:[1,0]
    v_cvt_pk_bf16_f32 v52, v160, v161
    v_cvt_pk_bf16_f32 v53, v162, v163
    v_pk_add_f32 v[172:173], v[172:173], v[46:47] op_sel_hi:[1,0]
    v_pk_add_f32 v[174:175], v[174:175], v[46:47] op_sel_hi:[1,0]
    v_cvt_pk_bf16_f32 v54, v172, v173
    v_cvt_pk_bf16_f32 v55, v174, v175
    s_mov_b64 exec, s[76:77]
    buffer_store_dwordx4 v[52:55], v7, s[44:47], s7 offen sc1
    s_mov_b64 exec, -1
    s_add_u32 s7, s7, s13
    v_pk_add_f32 v[164:165], v[164:165], v[48:49] op_sel_hi:[1,0]
    v_pk_add_f32 v[166:167], v[166:167], v[48:49] op_sel_hi:[1,0]
    v_cvt_pk_bf16_f32 v56, v164, v165
    v_cvt_pk_bf16_f32 v57, v166, v167
    v_pk_add_f32 v[176:177], v[176:177], v[48:49] op_sel_hi:[1,0]
    v_pk_add_f32 v[178:179], v[178:179], v[48:49] op_sel_hi:[1,0]
    v_cvt_pk_bf16_f32 v58, v176, v177
    v_cvt_pk_bf16_f32 v59, v178, v179
    s_mov_b64 exec, s[78:79]
    buffer_store_dwordx4 v[56:59], v7, s[44:47], s8 offen sc1
    s_mov_b64 exec, -1
    s_add_u32 s8, s8, s14
    v_pk_add_f32 v[180:181], v[180:181], v[44:45] op_sel_hi:[1,0]
    v_pk_add_f32 v[182:183], v[182:183], v[44:45] op_sel_hi:[1,0]
    v_cvt_pk_bf16_f32 v60, v180, v181
    v_cvt_pk_bf16_f32 v61, v182, v183
    v_pk_add_f32 v[192:193], v[192:193], v[44:45] op_sel_hi:[1,0]
    v_pk_add_f32 v[194:195], v[194:195], v[44:45] op_sel_hi:[1,0]
    v_cvt_pk_bf16_f32 v62, v192, v193
    v_cvt_pk_bf16_f32 v63, v194, v195
    s_mov_b64 exec, s[74:75]
    buffer_store_dwordx4 v[60:63], v7, s[44:47], s6 offen sc1
    s_mov_b64 exec, -1
    s_add_u32 s6, s6, s9
    v_pk_add_f32 v[184:185], v[184:185], v[46:47] op_sel_hi:[1,0]
    v_pk_add_f32 v[186:187], v[186:187], v[46:47] op_sel_hi:[1,0]
    v_cvt_pk_bf16_f32 v64, v184, v185
    v_cvt_pk_bf16_f32 v65, v186, v187
    v_pk_add_f32 v[196:197], v[196:197], v[46:47] op_sel_hi:[1,0]
    v_pk_add_f32 v[198:199], v[198:199], v[46:47] op_sel_hi:[1,0]
    v_cvt_pk_bf16_f32 v66, v196, v197
    v_cvt_pk_bf16_f32 v67, v198, v199
    s_mov_b64 exec, s[76:77]
    buffer_store_dwordx4 v[64:67], v7, s[44:47], s7 offen sc1
    s_mov_b64 exec, -1
    s_add_u32 s7, s7, s13
    v_pk_add_f32 v[188:189], v[188:189], v[48:49] op_sel_hi:[1,0]
    v_pk_add_f32 v[190:191], v[190:191], v[48:49] op_sel_hi:[1,0]
    v_cvt_pk_bf16_f32 v52, v188, v189
    v_cvt_pk_bf16_f32 v53, v190, v191
    v_pk_add_f32 v[200:201], v[200:201], v[48:49] op_sel_hi:[1,0]
    v_pk_add_f32 v[202:203], v[202:203], v[48:49] op_sel_hi:[1,0]
    v_cvt_pk_bf16_f32 v54, v200, v201
    v_cvt_pk_bf16_f32 v55, v202, v203
    s_mov_b64 exec, s[78:79]
    buffer_store_dwordx4 v[52:55], v7, s[44:47], s8 offen sc1
    s_mov_b64 exec, -1
    s_add_u32 s8, s8, s14
    v_pk_add_f32 v[204:205], v[204:205], v[44:45] op_sel_hi:[1,0]
    v_pk_add_f32 v[206:207], v[206:207], v[44:45] op_sel_hi:[1,0]
    v_cvt_pk_bf16_f32 v56, v204, v205
    v_cvt_pk_bf16_f32 v57, v206, v207
    v_pk_add_f32 v[216:217], v[216:217], v[44:45] op_sel_hi:[1,0]
    v_pk_add_f32 v[218:219], v[218:219], v[44:45] op_sel_hi:[1,0]
    v_cvt_pk_bf16_f32 v58, v216, v217
    v_cvt_pk_bf16_f32 v59, v218, v219
    s_mov_b64 exec, s[74:75]
    buffer_store_dwordx4 v[56:59], v7, s[44:47], s6 offen sc1
    s_mov_b64 exec, -1
    s_add_u32 s6, s6, s9
    v_pk_add_f32 v[208:209], v[208:209], v[46:47] op_sel_hi:[1,0]
    v_pk_add_f32 v[210:211], v[210:211], v[46:47] op_sel_hi:[1,0]
    v_cvt_pk_bf16_f32 v60, v208, v209
    v_cvt_pk_bf16_f32 v61, v210, v211
    v_pk_add_f32 v[220:221], v[220:221], v[46:47] op_sel_hi:[1,0]
    v_pk_add_f32 v[222:223], v[222:223], v[46:47] op_sel_hi:[1,0]
    v_cvt_pk_bf16_f32 v62, v220, v221
    v_cvt_pk_bf16_f32 v63, v222, v223
    s_mov_b64 exec, s[76:77]
    buffer_store_dwordx4 v[60:63], v7, s[44:47], s7 offen sc1
    s_mov_b64 exec, -1
    s_add_u32 s7, s7, s13
    v_pk_add_f32 v[212:213], v[212:213], v[48:49] op_sel_hi:[1,0]
    v_pk_add_f32 v[214:215], v[214:215], v[48:49] op_sel_hi:[1,0]
    v_cvt_pk_bf16_f32 v64, v212, v213
    v_cvt_pk_bf16_f32 v65, v214, v215
    v_pk_add_f32 v[224:225], v[224:225], v[48:49] op_sel_hi:[1,0]
    v_pk_add_f32 v[226:227], v[226:227], v[48:49] op_sel_hi:[1,0]
    v_cvt_pk_bf16_f32 v66, v224, v225
    v_cvt_pk_bf16_f32 v67, v226, v227
    s_mov_b64 exec, s[78:79]
    buffer_store_dwordx4 v[64:67], v7, s[44:47], s8 offen sc1
    s_mov_b64 exec, -1
    s_add_u32 s8, s8, s14
    s_cmp_ge_u32 s3, 2
    s_cbranch_scc1 L_skip_32
    v_pk_add_f32 v[228:229], v[228:229], v[44:45] op_sel_hi:[1,0]
    v_pk_add_f32 v[230:231], v[230:231], v[44:45] op_sel_hi:[1,0]
    v_cvt_pk_bf16_f32 v52, v228, v229
    v_cvt_pk_bf16_f32 v53, v230, v231
    v_pk_add_f32 v[240:241], v[240:241], v[44:45] op_sel_hi:[1,0]
    v_pk_add_f32 v[242:243], v[242:243], v[44:45] op_sel_hi:[1,0]
    v_cvt_pk_bf16_f32 v54, v240, v241
    v_cvt_pk_bf16_f32 v55, v242, v243
    s_mov_b64 exec, s[74:75]
    buffer_store_dwordx4 v[52:55], v7, s[44:47], s6 offen sc1
    s_mov_b64 exec, -1
    s_add_u32 s6, s6, s9
    v_pk_add_f32 v[232:233], v[232:233], v[46:47] op_sel_hi:[1,0]
    v_pk_add_f32 v[234:235], v[234:235], v[46:47] op_sel_hi:[1,0]
    v_cvt_pk_bf16_f32 v56, v232, v233
    v_cvt_pk_bf16_f32 v57, v234, v235
    v_pk_add_f32 v[244:245], v[244:245], v[46:47] op_sel_hi:[1,0]
    v_pk_add_f32 v[246:247], v[246:247], v[46:47] op_sel_hi:[1,0]
    v_cvt_pk_bf16_f32 v58, v244, v245
    v_cvt_pk_bf16_f32 v59, v246, v247
    s_mov_b64 exec, s[76:77]
    buffer_store_dwordx4 v[56:59], v7, s[44:47], s7 offen sc1
    s_mov_b64 exec, -1
    s_add_u32 s7, s7, s13
    v_pk_add_f32 v[236:237], v[236:237], v[48:49] op_sel_hi:[1,0]
    v_pk_add_f32 v[238:239], v[238:239], v[48:49] op_sel_hi:[1,0]
    v_cvt_pk_bf16_f32 v60, v236, v237
    v_cvt_pk_bf16_f32 v61, v238, v239
    v_pk_add_f32 v[248:249], v[248:249], v[48:49] op_sel_hi:[1,0]
    v_pk_add_f32 v[250:251], v[250:251], v[48:49] op_sel_hi:[1,0]
    v_cvt_pk_bf16_f32 v62, v248, v249
    v_cvt_pk_bf16_f32 v63, v250, v251
    s_mov_b64 exec, s[78:79]
    buffer_store_dwordx4 v[60:63], v7, s[44:47], s8 offen sc1
    s_mov_b64 exec, -1
    s_add_u32 s8, s8, s14
L_skip_32:
    s_mov_b32 exec_lo, 0xffff0000
    s_mov_b32 exec_hi, 0x0
    v_mov_b32 v28, v29
    s_mov_b32 exec_lo, 0x0
    s_mov_b32 exec_hi, 0xffff
    v_mov_b32 v28, v30
    s_mov_b32 exec_lo, 0x0
    s_mov_b32 exec_hi, 0xffff0000
    v_mov_b32 v28, v31
    s_mul_i32 s5, s11, 640
    s_mul_i32 s15, s10, 192
    s_add_u32 s5, s5, s15
    s_add_u32 s5, s5, 135168
    s_cmp_eq_u32 s10, 2
    s_cselect_b32 exec_hi, -1, 0xffff
    s_mov_b32 exec_lo, -1
    v_lshlrev_b32 v8, 2, v1
    s_cmp_lg_u32 s3, 0
    s_nop 0
    s_cbranch_scc1 L_skip_33
    buffer_store_dword v28, v8, s[44:47], s5 offen sc1
L_skip_33:
    s_mov_b64 exec, -1
    s_lshl_b32 s8, s12, 7
    s_add_u32 s8, s8, 86016
    s_waitcnt vmcnt(0) lgkmcnt(0)
    s_barrier
    s_cmp_lg_u32 s3, 0
    s_cbranch_scc1 L_skip_34
    s_mov_b32 exec_lo, 0xff
    s_mov_b32 exec_hi, 0x0
    buffer_store_dwordx4 v[2:5], v4, s[44:47], s8 offen sc1
    s_mov_b64 exec, -1
    s_nop 0
L_skip_34:
L_main_nc:
    s_lshr_b32 s5, s68, 2
    s_mul_i32 s5, s5, 144
    s_mul_i32 s6, s3, 36
    s_add_u32 s5, s5, s6
    s_lshl_b32 s5, s5, 7
    s_add_u32 s5, s5, 147456
    s_lshr_b32 s6, s71, 1
    s_lshl_b32 s6, s6, 11
    s_lshl_b32 s7, s3, 9
    s_add_u32 s6, s6, s7
    s_add_u32 s6, s6, 89600
    v_mov_b32 v16, s5
    v_mov_b32 v17, s6
    v_cmp_gt_u32 vcc, 36, v1
    s_nop 1
    v_cndmask_b32 v16, v17, v16, vcc
    v_lshl_add_u32 v16, v1, 7, v16
    v_accvgpr_write_b32 a224, v16
    v_and_b32 v13, 7, v2
    v_lshrrev_b32 v14, 3, v2
    s_and_b32 s8, s3, 1
    v_lshlrev_b32 v12, 7, v3
    v_lshl_add_u32 v12, v13, 4, v12
    v_mul_u32_u24 v15, 18432, v14
    v_add_u32 v15, v15, v12
    v_accvgpr_write_b32 a225, v15
    s_mov_b32 s43, 0
    s_mul_i32 s86, s72, 36864
    s_add_u32 s86, s86, 11059200
    v_and_b32 v8, 3, v1
    v_bfe_u32 v9, v1, 2, 2
    s_mul_i32 s5, s3, 8448
    s_add_u32 s5, s5, 129024
    v_mul_u32_u24 v6, 264, v2
    v_mad_u32_u24 v6, v3, 40, v6
    v_add_u32 v6, s5, v6
    v_accvgpr_write_b32 a200, v6
    v_and_b32 v6, 1, v3
    v_lshlrev_b32 v6, 4, v6
    v_lshl_add_u32 v6, v9, 2, v6
    v_and_b32 v7, 2, v3
    v_add_u32 v6, v6, v7
    v_mul_u32_u24 v10, 264, v6
    v_add_u32 v10, 129024, v10
    s_lshr_b32 s7, s3, 1
    s_mul_i32 s5, s7, 80
    v_lshrrev_b32 v6, 1, v8
    v_mad_u32_u24 v11, v6, 40, v10
    v_add_u32 v11, s5, v11
    v_and_b32 v6, 1, v8
    v_mad_u32_u24 v7, v6, 24, v11
    v_add_u32 v7, 0, v7
    v_accvgpr_write_b32 a201, v7
    v_mad_u32_u24 v7, v6, 24, v11
    v_add_u32 v7, 8, v7
    v_accvgpr_write_b32 a202, v7
    v_mad_u32_u24 v7, v6, 16, v11
    v_add_u32 v7, 16, v7
    v_accvgpr_write_b32 a203, v7
    s_mul_i32 s5, s3, 24
    s_add_u32 s5, s5, 160
    v_min_u32 v6, 2, v8
    v_lshl_add_u32 v6, v6, 3, v10
    v_add_u32 v6, s5, v6
    v_accvgpr_write_b32 a204, v6
    s_mul_i32 s5, s3, 960
    v_lshlrev_b32 v6, 6, v2
    v_lshl_add_u32 v6, v3, 4, v6
    v_add_u32 v6, s5, v6
    v_accvgpr_write_b32 a205, v6
    v_lshrrev_b32 v6, 1, v3
    v_lshl_add_u32 v6, v2, 1, v6
    v_lshlrev_b32 v6, 4, v6
    s_add_u32 s5, s5, 640
    v_add_u32 v6, s5, v6
    v_accvgpr_write_b32 a220, v6
    s_mul_i32 s5, s68, 15
    v_lshrrev_b32 v6, 4, v0
    v_min_u32 v7, 14, v6
    v_add_u32 v7, s5, v7
    v_lshlrev_b32 v7, 4, v7
    v_lshl_add_u32 v7, v2, 12, v7
    v_accvgpr_write_b32 a206, v7
    v_and_b32 v13, 7, v2
    v_lshrrev_b32 v14, 3, v2
    s_and_b32 s8, s3, 1
    s_mul_i32 s5, s73, 36864
    s_mul_i32 s6, s8, 18432
    s_add_u32 s5, s5, s6
    s_mul_i32 s6, s71, 2304
    s_add_u32 s5, s5, s6
    v_lshlrev_b32 v12, 7, v3
    v_lshl_add_u32 v12, v13, 4, v12
    v_add_u32 v12, s5, v12
    v_lshl_add_u32 v15, v14, 3, v12
    v_accvgpr_write_b32 a226, v15
    v_lshl_add_u32 v15, v14, 9, v12
    v_accvgpr_write_b32 a217, v15
    v_and_b32 v16, 3, v2
    v_lshlrev_b32 v15, 8, v3
    v_lshl_add_u32 v15, v16, 6, v15
    v_lshrrev_b32 v16, 2, v2
    v_lshl_add_u32 v15, v16, 4, v15
    v_accvgpr_write_b32 a222, v15
    s_lshl_b32 s5, s72, 10
    s_add_u32 s5, s5, 946176
    v_lshlrev_b32 v15, 9, v14
    v_lshl_add_u32 v15, v3, 6, v15
    v_lshl_add_u32 v15, v13, 2, v15
    v_add_u32 v15, s5, v15
    v_accvgpr_write_b32 a228, v15
    s_mov_b32 s87, 11059200
    s_lshl_b32 s15, s68, 11
    s_add_u32 s15, s15, 225280
    s_mov_b32 s80, 0x00100001
    s_mov_b32 s81, 0x10000100
    s_lshl_b32 s88, s69, 16
    s_add_u32 s88, s88, 1142784
    s_lshl_b32 s89, s69, 12
    s_add_u32 s89, s89, 1011712
    s_mov_b32 s90, 290816
    v_lshrrev_b32 v6, 4, v0
    s_lshl_b32 s5, s68, 8
    v_lshl_add_u32 v6, v6, 4, s5
    v_accvgpr_write_b32 a207, v6
    v_mul_u32_u24 v6, 4370, v0
    v_lshrrev_b32 v6, 16, v6
    v_add_lshl_u32 v6, v6, v0, 4
    v_accvgpr_write_b32 a221, v6
    s_movk_i32 s7, 240
    v_cmp_gt_u32 s[76:77], s7, v0
    v_mul_u32_u24 v12, 1093, v0
    v_lshrrev_b32 v12, 16, v12
    v_mul_u32_u24 v13, 60, v12
    v_sub_u32 v13, v0, v13
    v_cmp_le_u32 vcc, 40, v13
    v_lshrrev_b32 v14, 2, v13
    v_subrev_u32 v15, 40, v13
    v_lshrrev_b32 v15, 1, v15
    v_cndmask_b32 v14, v14, v15, vcc
    v_and_b32 v15, 3, v13
    v_mul_u32_u24 v15, 24, v15
    v_and_b32 v16, 1, v13
    v_mad_u32_u24 v16, v16, 48, 12
    v_cndmask_b32 v15, v15, v16, vcc
    v_and_b32 v16, 1, v12
    v_mad_u32_u24 v16, v16, 9, v14
    v_cmp_ne_u32 vcc, 18, v16
    s_nop 0
    s_and_b64 s[78:79], s[76:77], vcc
    v_cmp_eq_u32 vcc, 9, v14
    v_mov_b32 v17, 18
    s_nop 0
    v_cndmask_b32 v16, v16, v17, vcc
    v_lshrrev_b32 v12, 1, v12
    v_mad_u32_u24 v16, v12, 19, v16
    v_mul_u32_u24 v16, 96, v16
    v_add_u32 v16, v16, v15
    v_add_u32 v16, 86016, v16
    v_accvgpr_write_b32 a208, v16
    v_add_u32 v16, 12, v16
    v_mul_u32_u24 v17, 12, v0
    v_add_u32 v17, 86784, v17
    v_cndmask_b32 v16, v17, v16, s[76:77]
    v_accvgpr_write_b32 a223, v16
    v_cmp_gt_u32 vcc, 40, v13
    s_nop 0
    s_and_b64 s[74:75], s[78:79], vcc
    s_mov_b32 vcc_lo, 0xaaaaaaaa
    s_mov_b32 vcc_hi, 0xaaaaaaaa
    s_and_b64 s[74:75], s[74:75], vcc
    s_orn2_b64 s[74:75], s[74:75], s[76:77]
    v_lshrrev_b32 v12, 3, v2
    v_lshrrev_b32 v13, 1, v3
    v_cmp_eq_u32 vcc, v12, v13
    v_mul_u32_u24 v12, 1824, v12
    v_and_b32 v13, 1, v3
    v_mad_u32_u24 v12, v13, 48, v12
    v_add_u32 v12, 86016, v12
    v_bfe_u32 v13, v2, 2, 1
    v_and_b32 v14, 3, v2
    v_lshl_add_u32 v13, v13, 3, v14
    v_mov_b32 v17, 89664
    s_movk_i32 s5, 96
    v_add_u32 v15, 0, v13
    v_mad_u32_u24 v15, v15, s5, v12
    v_cndmask_b32 v15, v17, v15, vcc
    v_accvgpr_write_b32 a209, v15
    v_add_u32 v15, 4, v13
    v_mad_u32_u24 v15, v15, s5, v12
    v_cndmask_b32 v15, v17, v15, vcc
    v_accvgpr_write_b32 a210, v15
    v_lshlrev_b32 v15, 3, v14
    v_mov_b32 v18, 0x12111012
    v_lshrrev_b32 v15, v15, v18
    v_and_b32 v15, 0xff, v15
    v_mad_u32_u24 v15, v15, s5, v12
    v_cndmask_b32 v15, v17, v15, vcc
    v_accvgpr_write_b32 a211, v15
    s_mul_i32 s5, s72, 36864
    v_lshrrev_b32 v12, 3, v2
    v_mul_u32_u24 v12, 18432, v12
    v_and_b32 v13, 7, v2
    v_lshl_add_u32 v12, v13, 4, v12
    v_add_u32 v12, s5, v12
    s_lshl_b32 s5, s69, 10
    v_lshl_add_u32 v14, v3, 8, v12
    v_add_u32 v14, s5, v14
    v_accvgpr_write_b32 a212, v14
    s_lshl_b32 s5, s69, 7
    s_add_u32 s5, s5, 16384
    v_lshlrev_b32 v14, 3, v13
    v_sub_u32 v14, v12, v14
    v_lshrrev_b32 v15, 1, v3
    v_lshl_add_u32 v14, v15, 6, v14
    v_add_u32 v14, s5, v14
    v_accvgpr_write_b32 a213, v14
    v_and_b32 v13, 7, v2
    s_and_b32 s8, s3, 1
    s_mul_i32 s5, s73, 36864
    s_mul_i32 s6, s71, 4608
    s_add_u32 s5, s5, s6
    s_lshl_b32 s6, s8, 7
    s_add_u32 s5, s5, s6
    v_lshlrev_b32 v12, 8, v3
    v_lshl_add_u32 v12, v13, 4, v12
    v_add_u32 v12, s5, v12
    v_lshrrev_b32 v14, 3, v2
    v_lshl_add_u32 v15, v14, 3, v12
    v_accvgpr_write_b32 a214, v15
    s_lshl_b32 s5, s70, 13
    s_lshl_b32 s6, s3, 8
    s_add_u32 s5, s5, s6
    s_add_u32 s5, s5, 684032
    v_lshl_add_u32 v15, v2, 4, s5
    v_lshl_add_u32 v16, v3, 10, v15
    v_accvgpr_write_b32 a216, v16
    s_lshl_b32 s6, s71, 10
    v_add_u32 v15, s6, v15
    v_accvgpr_write_b32 a215, v15
    s_lshl_b32 s5, s73, 5
    s_lshl_b32 s6, s8, 3
    s_add_u32 s5, s5, s6
    s_mul_i32 s5, s5, 1152
    s_mul_i32 s6, s71, 144
    s_add_u32 s5, s5, s6
    v_lshl_add_u32 v15, v14, 4, v13
    v_mul_u32_u24 v15, 1152, v15
    v_and_b32 v16, 1, v3
    v_lshl_add_u32 v15, v16, 5, v15
    v_lshrrev_b32 v16, 1, v3
    v_lshl_add_u32 v15, v16, 4, v15
    v_add_u32 v15, s5, v15
    v_accvgpr_write_b32 a218, v15
    v_lshlrev_b32 v15, 7, v3
    v_lshl_add_u32 v15, v13, 4, v15
    v_add_u32 v15, 4096, v15
    v_accvgpr_write_b32 a219, v15
    s_lshl_b32 s5, s72, 4
    s_add_u32 s5, s5, s69
    s_lshl_b32 s5, s5, 7
    s_add_u32 s5, s5, 290816
    v_accvgpr_read_b32 v15, a215
    v_writelane_b32 v15, s5, 1
    s_add_u32 s5, s5, 131072
    v_writelane_b32 v15, s5, 2
    s_lshl_b32 s5, s73, 4
    s_lshl_b32 s6, s71, 1
    s_add_u32 s5, s5, s6
    s_and_b32 s6, s3, 1
    s_add_u32 s5, s5, s6
    s_lshl_b32 s5, s5, 7
    s_add_u32 s5, s5, 552960
    v_writelane_b32 v15, s5, 3
    s_lshl_b32 s5, s69, 7
    s_add_u32 s5, s5, s15
    v_writelane_b32 v15, s5, 4
    s_add_u32 s5, s5, 32768
    v_writelane_b32 v15, s5, 5
    s_lshl_b32 s5, s70, 2
    s_add_u32 s5, s5, s3
    s_lshl_b32 s5, s5, 3
    s_add_u32 s5, s5, s71
    s_lshl_b32 s5, s5, 6
    s_add_u32 s5, s5, 946176
    v_writelane_b32 v15, s5, 6
    v_accvgpr_write_b32 a227, v15
    v_lshl_add_u32 v15, v2, 2, s5
    v_accvgpr_write_b32 a229, v15
    s_nop 1
L_nc2:
    v_mov_b64 v[180:181], 0
    v_mov_b64 v[182:183], 0
    s_lshl_b32 s5, s72, 4
    s_add_u32 s5, s5, s69
    s_lshl_b32 s5, s5, 7
    s_add_u32 s5, s5, 290816
    s_add_u32 s6, s5, 131072
    s_lshl_b32 s7, s73, 4
    s_lshl_b32 s8, s71, 1
    s_add_u32 s7, s7, s8
    s_and_b32 s8, s3, 1
    s_add_u32 s7, s7, s8
    s_lshl_b32 s7, s7, 7
    s_add_u32 s7, s7, 552960
    s_mov_b32 exec_lo, 0xff
    s_mov_b32 exec_hi, 0x0
    buffer_store_dwordx4 v[180:183], v4, s[44:47], s5 offen sc1
    buffer_store_dwordx4 v[180:183], v4, s[44:47], s6 offen sc1
    buffer_store_dwordx4 v[180:183], v4, s[44:47], s7 offen sc1
    s_lshl_b32 s5, s69, 7
    s_add_u32 s5, s5, s15
    s_add_u32 s6, s5, 32768
    s_cmp_lg_u32 s3, 0
    s_cbranch_scc1 L_skip_35
    buffer_store_dwordx4 v[180:183], v4, s[44:47], s5 offen sc1
    buffer_store_dwordx4 v[180:183], v4, s[44:47], s6 offen sc1
    s_nop 1
L_skip_35:
    s_mov_b64 exec, -1
    v_accvgpr_read_b32 v184, a215
    v_accvgpr_read_b32 v185, a207
    s_lshl_b32 s5, s68, 12
    s_mul_i32 s6, s3, 960
    s_add_u32 s5, s5, s6
    s_add_u32 s5, s5, s88
    s_add_u32 s6, s5, 1048576
    s_add_u32 s7, s89, 65536
    s_mov_b32 exec_lo, 0xffffffff
    s_mov_b32 exec_hi, 0xfffffff
    buffer_store_dwordx4 v[180:183], v4, s[44:47], s5 offen sc1
    buffer_store_dwordx4 v[180:183], v4, s[44:47], s6 offen sc1
    s_mov_b32 exec_lo, 0x10001
    s_mov_b32 exec_hi, 0x10001
    buffer_store_dwordx4 v[180:183], v185, s[44:47], s89 offen sc1
    buffer_store_dwordx4 v[180:183], v185, s[44:47], s7 offen sc1
    s_mov_b32 exec_lo, 0xffff
    s_mov_b32 exec_hi, 0x0
    buffer_store_dwordx4 v[180:183], v184, s[44:47], 0 offen sc1
    v_accvgpr_read_b32 v184, a229
    buffer_store_dword v180, v184, s[44:47], 0 offen sc1
    s_mov_b64 exec, -1
L_nc3:
    s_lshl_b32 s91, s3, 10
    s_mul_i32 s97, s69, 129024
    s_add_u32 s97, s97, 3293184
    v_lshlrev_b32 v10, 11, v1
    s_lshl_b32 s5, s69, 7
    s_add_u32 s5, s5, 86016
    s_mov_b64 exec, 7
    s_mov_b32 s42, 400000
L_poll_36:
    buffer_load_dword v11, v10, s[44:47], s5 offen offset:12 sc1
    s_waitcnt vmcnt(0)
    v_cmp_ne_u32 vcc, s4, v11
    s_nop 1
    s_cbranch_vccz L_polld_37
    s_mov_b64 exec, vcc
    s_sub_u32 s42, s42, 1
    s_cbranch_scc0 L_poll_36
L_polld_37:
    s_mov_b64 exec, -1
    s_cmp_ge_u32 s91, 129024
    s_cbranch_scc1 L_wdone_39
L_wrest_38:
    s_add_u32 s92, s97, s91
    s_mov_b32 m0, s91
    s_add_u32 s91, s91, 4096
    buffer_load_dwordx4 v4, s[44:47], s92 offen sc1 lds
    s_cmp_lt_u32 s91, 129024
    s_cbranch_scc1 L_wrest_38
L_wdone_39:
    s_and_b32 s5, s2, 7
    s_lshl_b32 s5, s5, 7
    s_add_u32 s5, s5, 221184
    v_mov_b32 v6, 0
    s_mov_b64 exec, 1
    s_mov_b32 s42, 400000
L_poll_40:
    buffer_load_dword v7, v6, s[44:47], s5 offen offset:12 sc1
    s_waitcnt vmcnt(0)
    v_cmp_ne_u32 vcc, s4, v7
    s_nop 1
    s_cbranch_vccz L_polld_41
    s_mov_b64 exec, vcc
    s_sub_u32 s42, s42, 1
    s_cbranch_scc0 L_poll_40
L_polld_41:
    s_mov_b64 exec, -1
L_cv2:
L_main:
    v_accvgpr_read_b32 v6, a224
    v_accvgpr_read_b32 v6, a224
    v_accvgpr_read_b32 v8, a227
    v_lshlrev_b32 v9, 7, v2
    s_lshl_b32 s93, s68, 11
    s_add_u32 s93, s93, 102400
    s_mov_b32 exec_lo, 0xffff
    s_mov_b32 exec_hi, 0x0
    buffer_load_dword a230, v8, s[44:47], 0 offen sc1
    s_mov_b64 exec, -1
    s_mov_b32 exec_lo, 0xffffffff
    s_mov_b32 exec_hi, 0xff
    s_mov_b32 s42, 400000
L_poll_42:
    buffer_load_dword v7, v6, s[44:47], 0 offen offset:12 sc1
    buffer_load_dwordx4 v[12:15], v9, s[44:47], s93 offen sc1
    s_waitcnt vmcnt(0)
    v_cmp_ne_u32 vcc, s4, v7
    v_cmp_ne_u32 s[82:83], s4, v15
    s_nop 0
    s_or_b64 vcc, vcc, s[82:83]
    s_nop 2
    s_cbranch_vccz L_polld_43
    s_mov_b64 exec, vcc
    s_sub_u32 s42, s42, 1
    s_cbranch_scc0 L_poll_42
L_polld_43:
    s_mov_b64 exec, -1
    s_mov_b32 exec_lo, 0xffff
    s_mov_b32 exec_hi, 0x0
    v_cmp_ne_u32 vcc, s100, v14
    s_mov_b64 exec, -1
    s_cmp_eq_u64 vcc, 0
    s_cselect_b32 s13, 1, 0
    s_barrier
L_layer:
    v_accvgpr_read_b32 v9, a225
    buffer_load_dwordx4 v[112:115], v9, s[44:47], s86 offen sc1
    buffer_load_dwordx4 v[116:119], v9, s[44:47], s86 offen offset:512 sc1
    buffer_load_dwordx4 v[120:123], v9, s[44:47], s86 offen offset:1024 sc1
    buffer_load_dwordx4 v[124:127], v9, s[44:47], s86 offen offset:1536 sc1
    buffer_load_dwordx4 v[128:131], v9, s[44:47], s86 offen offset:2048 sc1
    buffer_load_dwordx4 v[132:135], v9, s[44:47], s86 offen offset:2560 sc1
    s_cmp_eq_u32 s43, 0
    s_cbranch_scc1 L_skip_44
    s_waitcnt vmcnt(6)
    s_barrier
L_skip_44:
    v_accvgpr_read_b32 v8, a222
    v_add_u32 v6, 46080, v8
    v_add_u32 v7, 92160, v8
    v_accvgpr_read_b32 v42, a226
    v_accvgpr_read_b32 v41, a228
    s_mul_i32 s6, s69, 640
    s_add_u32 s6, s6, 135360
    v_lshlrev_b32 v40, 4, v3
    s_cmp_lg_u32 s43, 0
    s_cselect_b64 vcc, -1, 0
    ds_read_b128 a[0:3], v8 offset:0
    ds_read_b128 a[4:7], v8 offset:1024
    ds_read_b128 a[8:11], v8 offset:2048
    ds_read_b128 a[12:15], v8 offset:3072
    ds_read_b128 a[16:19], v8 offset:4096
    s_waitcnt vmcnt(4)
    v_swap_b32 v114, v116
    v_swap_b32 v115, v117
    s_waitcnt lgkmcnt(4)
    s_nop 0
    v_mfma_f32_16x16x32_bf16 v[48:51], a[0:3], v[112:115], 0
    ds_read_b128 a[20:23], v8 offset:5120
    v_mfma_f32_16x16x32_bf16 v[76:79], a[0:3], v[116:119], 0
    buffer_load_dwordx4 v[136:139], v9, s[44:47], s86 offen offset:3072 sc1
    s_waitcnt lgkmcnt(4)
    v_mfma_f32_16x16x32_bf16 v[52:55], a[4:7], v[112:115], 0
    ds_read_b128 a[24:27], v8 offset:6144
    v_mfma_f32_16x16x32_bf16 v[80:83], a[4:7], v[116:119], 0
    buffer_load_dwordx4 v[140:143], v9, s[44:47], s86 offen offset:3584 sc1
    s_waitcnt lgkmcnt(4)
    v_mfma_f32_16x16x32_bf16 v[56:59], a[8:11], v[112:115], 0
    ds_read_b128 a[28:31], v8 offset:7168
    v_mfma_f32_16x16x32_bf16 v[84:87], a[8:11], v[116:119], 0
    s_waitcnt vmcnt(4)
    v_swap_b32 v122, v124
    s_waitcnt lgkmcnt(4)
    v_mfma_f32_16x16x32_bf16 v[60:63], a[12:15], v[112:115], 0
    ds_read_b128 a[32:35], v8 offset:8192
    v_mfma_f32_16x16x32_bf16 v[88:91], a[12:15], v[116:119], 0
    v_swap_b32 v123, v125
    s_waitcnt lgkmcnt(4)
    v_mfma_f32_16x16x32_bf16 v[64:67], a[16:19], v[112:115], 0
    ds_read_b128 a[36:39], v8 offset:9216
    v_mfma_f32_16x16x32_bf16 v[92:95], a[16:19], v[116:119], 0
    s_add_u32 s86, s86, 4096
    buffer_load_dwordx4 v[144:147], v9, s[44:47], s86 offen sc1
    s_waitcnt lgkmcnt(4)
    v_mfma_f32_16x16x32_bf16 v[48:51], a[20:23], v[120:123], v[48:51]
    ds_read_b128 a[0:3], v8 offset:10240
    v_mfma_f32_16x16x32_bf16 v[76:79], a[20:23], v[124:127], v[76:79]
    buffer_load_dwordx4 v[148:151], v9, s[44:47], s86 offen offset:512 sc1
    s_waitcnt lgkmcnt(4)
    v_mfma_f32_16x16x32_bf16 v[52:55], a[24:27], v[120:123], v[52:55]
    ds_read_b128 a[4:7], v8 offset:11264
    v_mfma_f32_16x16x32_bf16 v[80:83], a[24:27], v[124:127], v[80:83]
    buffer_load_dwordx4 v[152:155], v9, s[44:47], s86 offen offset:1024 sc1
    s_waitcnt lgkmcnt(4)
    v_mfma_f32_16x16x32_bf16 v[56:59], a[28:31], v[120:123], v[56:59]
    ds_read_b128 a[8:11], v8 offset:12288
    v_mfma_f32_16x16x32_bf16 v[84:87], a[28:31], v[124:127], v[84:87]
    s_waitcnt vmcnt(5)
    v_swap_b32 v130, v132
    s_waitcnt lgkmcnt(4)
    v_mfma_f32_16x16x32_bf16 v[60:63], a[32:35], v[120:123], v[60:63]
    ds_read_b128 a[12:15], v8 offset:13312
    v_mfma_f32_16x16x32_bf16 v[88:91], a[32:35], v[124:127], v[88:91]
    v_swap_b32 v131, v133
    s_waitcnt lgkmcnt(4)
    v_mfma_f32_16x16x32_bf16 v[64:67], a[36:39], v[120:123], v[64:67]
    ds_read_b128 a[16:19], v8 offset:14336
    v_mfma_f32_16x16x32_bf16 v[92:95], a[36:39], v[124:127], v[92:95]
    buffer_load_dwordx4 v[156:159], v9, s[44:47], s86 offen offset:1536 sc1
    s_cbranch_vccnz L_skip_45
    v_mfma_f32_16x16x32_bf16 v[104:107], v[112:115], v[112:115], 0
    v_mfma_f32_16x16x32_bf16 v[108:111], v[116:119], v[116:119], 0
    v_mfma_f32_16x16x32_bf16 v[104:107], v[120:123], v[120:123], v[104:107]
    v_mfma_f32_16x16x32_bf16 v[108:111], v[124:127], v[124:127], v[108:111]
    v_mfma_f32_16x16x32_bf16 v[104:107], v[128:131], v[128:131], v[104:107]
    v_mfma_f32_16x16x32_bf16 v[108:111], v[132:135], v[132:135], v[108:111]
L_skip_45:
    s_waitcnt lgkmcnt(4)
    v_mfma_f32_16x16x32_bf16 v[48:51], a[0:3], v[128:131], v[48:51]
    ds_read_b128 a[20:23], v8 offset:15360
    v_mfma_f32_16x16x32_bf16 v[76:79], a[0:3], v[132:135], v[76:79]
    buffer_load_dwordx4 v[160:163], v9, s[44:47], s86 offen offset:2048 sc1
    s_waitcnt lgkmcnt(4)
    v_mfma_f32_16x16x32_bf16 v[52:55], a[4:7], v[128:131], v[52:55]
    ds_read_b128 a[24:27], v8 offset:16384
    v_mfma_f32_16x16x32_bf16 v[80:83], a[4:7], v[132:135], v[80:83]
    buffer_load_dwordx4 v[164:167], v9, s[44:47], s86 offen offset:2560 sc1
    s_waitcnt lgkmcnt(4)
    v_mfma_f32_16x16x32_bf16 v[56:59], a[8:11], v[128:131], v[56:59]
    ds_read_b128 a[28:31], v8 offset:17408
    v_mfma_f32_16x16x32_bf16 v[84:87], a[8:11], v[132:135], v[84:87]
    s_waitcnt vmcnt(6)
    v_swap_b32 v138, v140
    s_waitcnt lgkmcnt(4)
    v_mfma_f32_16x16x32_bf16 v[60:63], a[12:15], v[128:131], v[60:63]
    ds_read_b128 a[32:35], v8 offset:18432
    v_mfma_f32_16x16x32_bf16 v[88:91], a[12:15], v[132:135], v[88:91]
    v_swap_b32 v139, v141
    s_waitcnt lgkmcnt(4)
    v_mfma_f32_16x16x32_bf16 v[64:67], a[16:19], v[128:131], v[64:67]
    ds_read_b128 a[36:39], v8 offset:19456
    v_mfma_f32_16x16x32_bf16 v[92:95], a[16:19], v[132:135], v[92:95]
    buffer_load_dwordx4 v[168:171], v9, s[44:47], s86 offen offset:3072 sc1
    s_waitcnt lgkmcnt(4)
    v_mfma_f32_16x16x32_bf16 v[48:51], a[20:23], v[136:139], v[48:51]
    ds_read_b128 a[0:3], v8 offset:20480
    v_mfma_f32_16x16x32_bf16 v[76:79], a[20:23], v[140:143], v[76:79]
    buffer_load_dwordx4 v[172:175], v9, s[44:47], s86 offen offset:3584 sc1
    s_waitcnt lgkmcnt(4)
    v_mfma_f32_16x16x32_bf16 v[52:55], a[24:27], v[136:139], v[52:55]
    ds_read_b128 a[4:7], v8 offset:21504
    v_mfma_f32_16x16x32_bf16 v[80:83], a[24:27], v[140:143], v[80:83]
    s_add_u32 s86, s86, 4096
    buffer_load_dwordx4 v[176:179], v9, s[44:47], s86 offen sc1
    s_waitcnt lgkmcnt(4)
    v_mfma_f32_16x16x32_bf16 v[56:59], a[28:31], v[136:139], v[56:59]
    ds_read_b128 a[8:11], v8 offset:22528
    v_mfma_f32_16x16x32_bf16 v[84:87], a[28:31], v[140:143], v[84:87]
    s_waitcnt vmcnt(7)
    v_swap_b32 v146, v148
    s_waitcnt lgkmcnt(4)
    v_mfma_f32_16x16x32_bf16 v[60:63], a[32:35], v[136:139], v[60:63]
    ds_read_b128 a[12:15], v8 offset:23552
    v_mfma_f32_16x16x32_bf16 v[88:91], a[32:35], v[140:143], v[88:91]
    v_swap_b32 v147, v149
    s_waitcnt lgkmcnt(4)
    v_mfma_f32_16x16x32_bf16 v[64:67], a[36:39], v[136:139], v[64:67]
    ds_read_b128 a[16:19], v8 offset:24576
    v_mfma_f32_16x16x32_bf16 v[92:95], a[36:39], v[140:143], v[92:95]
    buffer_load_dwordx4 v[180:183], v9, s[44:47], s86 offen offset:512 sc1
    s_waitcnt lgkmcnt(4)
    v_mfma_f32_16x16x32_bf16 v[48:51], a[0:3], v[144:147], v[48:51]
    ds_read_b128 a[20:23], v8 offset:25600
    v_mfma_f32_16x16x32_bf16 v[76:79], a[0:3], v[148:151], v[76:79]
    buffer_load_dwordx4 v[184:187], v9, s[44:47], s86 offen offset:1024 sc1
    s_waitcnt lgkmcnt(4)
    v_mfma_f32_16x16x32_bf16 v[52:55], a[4:7], v[144:147], v[52:55]
    ds_read_b128 a[24:27], v8 offset:26624
    v_mfma_f32_16x16x32_bf16 v[80:83], a[4:7], v[148:151], v[80:83]
    buffer_load_dwordx4 v[188:191], v9, s[44:47], s86 offen offset:1536 sc1
    s_waitcnt lgkmcnt(4)
    v_mfma_f32_16x16x32_bf16 v[56:59], a[8:11], v[144:147], v[56:59]
    ds_read_b128 a[28:31], v8 offset:27648
    v_mfma_f32_16x16x32_bf16 v[84:87], a[8:11], v[148:151], v[84:87]
    s_waitcnt vmcnt(8)
    v_swap_b32 v154, v156
    s_waitcnt lgkmcnt(4)
    v_mfma_f32_16x16x32_bf16 v[60:63], a[12:15], v[144:147], v[60:63]
    ds_read_b128 a[32:35], v8 offset:28672
    v_mfma_f32_16x16x32_bf16 v[88:91], a[12:15], v[148:151], v[88:91]
    v_swap_b32 v155, v157
    s_waitcnt lgkmcnt(4)
    v_mfma_f32_16x16x32_bf16 v[64:67], a[16:19], v[144:147], v[64:67]
    ds_read_b128 a[36:39], v8 offset:29696
    v_mfma_f32_16x16x32_bf16 v[92:95], a[16:19], v[148:151], v[92:95]
    buffer_load_dwordx4 v[192:195], v9, s[44:47], s86 offen offset:2048 sc1
    s_cbranch_vccnz L_skip_46
    v_mfma_f32_16x16x32_bf16 v[104:107], v[136:139], v[136:139], v[104:107]
    v_mfma_f32_16x16x32_bf16 v[108:111], v[140:143], v[140:143], v[108:111]
    v_mfma_f32_16x16x32_bf16 v[104:107], v[144:147], v[144:147], v[104:107]
    v_mfma_f32_16x16x32_bf16 v[108:111], v[148:151], v[148:151], v[108:111]
    v_mfma_f32_16x16x32_bf16 v[104:107], v[152:155], v[152:155], v[104:107]
    v_mfma_f32_16x16x32_bf16 v[108:111], v[156:159], v[156:159], v[108:111]
L_skip_46:
    s_waitcnt lgkmcnt(4)
    v_mfma_f32_16x16x32_bf16 v[48:51], a[20:23], v[152:155], v[48:51]
    ds_read_b128 a[0:3], v8 offset:30720
    v_mfma_f32_16x16x32_bf16 v[76:79], a[20:23], v[156:159], v[76:79]
    buffer_load_dwordx4 v[196:199], v9, s[44:47], s86 offen offset:2560 sc1
    s_waitcnt lgkmcnt(4)
    v_mfma_f32_16x16x32_bf16 v[52:55], a[24:27], v[152:155], v[52:55]
    ds_read_b128 a[4:7], v8 offset:31744
    v_mfma_f32_16x16x32_bf16 v[80:83], a[24:27], v[156:159], v[80:83]
    buffer_load_dwordx4 v[200:203], v9, s[44:47], s86 offen offset:3072 sc1
    s_waitcnt lgkmcnt(4)
    v_mfma_f32_16x16x32_bf16 v[56:59], a[28:31], v[152:155], v[56:59]
    ds_read_b128 a[8:11], v8 offset:32768
    v_mfma_f32_16x16x32_bf16 v[84:87], a[28:31], v[156:159], v[84:87]
    s_waitcnt vmcnt(9)
    v_swap_b32 v162, v164
    s_waitcnt lgkmcnt(4)
    v_mfma_f32_16x16x32_bf16 v[60:63], a[32:35], v[152:155], v[60:63]
    ds_read_b128 a[12:15], v8 offset:33792
    v_mfma_f32_16x16x32_bf16 v[88:91], a[32:35], v[156:159], v[88:91]
    v_swap_b32 v163, v165
    s_waitcnt lgkmcnt(4)
    v_mfma_f32_16x16x32_bf16 v[64:67], a[36:39], v[152:155], v[64:67]
    ds_read_b128 a[16:19], v8 offset:34816
    v_mfma_f32_16x16x32_bf16 v[92:95], a[36:39], v[156:159], v[92:95]
    buffer_load_dwordx4 v[204:207], v9, s[44:47], s86 offen offset:3584 sc1
    s_waitcnt lgkmcnt(4)
    v_mfma_f32_16x16x32_bf16 v[48:51], a[0:3], v[160:163], v[48:51]
    ds_read_b128 a[20:23], v8 offset:35840
    v_mfma_f32_16x16x32_bf16 v[76:79], a[0:3], v[164:167], v[76:79]
    s_add_u32 s86, s86, 4096
    buffer_load_dwordx4 v[208:211], v9, s[44:47], s86 offen sc1
    s_waitcnt lgkmcnt(4)
    v_mfma_f32_16x16x32_bf16 v[52:55], a[4:7], v[160:163], v[52:55]
    ds_read_b128 a[24:27], v8 offset:36864
    v_mfma_f32_16x16x32_bf16 v[80:83], a[4:7], v[164:167], v[80:83]
    buffer_load_dwordx4 v[212:215], v9, s[44:47], s86 offen offset:512 sc1
    s_waitcnt lgkmcnt(4)
    v_mfma_f32_16x16x32_bf16 v[56:59], a[8:11], v[160:163], v[56:59]
    ds_read_b128 a[28:31], v8 offset:37888
    v_mfma_f32_16x16x32_bf16 v[84:87], a[8:11], v[164:167], v[84:87]
    s_waitcnt vmcnt(10)
    v_swap_b32 v170, v172
    s_waitcnt lgkmcnt(4)
    v_mfma_f32_16x16x32_bf16 v[60:63], a[12:15], v[160:163], v[60:63]
    ds_read_b128 a[32:35], v8 offset:38912
    v_mfma_f32_16x16x32_bf16 v[88:91], a[12:15], v[164:167], v[88:91]
    v_swap_b32 v171, v173
    s_waitcnt lgkmcnt(4)
    v_mfma_f32_16x16x32_bf16 v[64:67], a[16:19], v[160:163], v[64:67]
    ds_read_b128 a[36:39], v8 offset:39936
    v_mfma_f32_16x16x32_bf16 v[92:95], a[16:19], v[164:167], v[92:95]
    buffer_load_dwordx4 v[216:219], v9, s[44:47], s86 offen offset:1024 sc1
    s_waitcnt lgkmcnt(4)
    v_mfma_f32_16x16x32_bf16 v[48:51], a[20:23], v[168:171], v[48:51]
    ds_read_b128 a[0:3], v8 offset:40960
    v_mfma_f32_16x16x32_bf16 v[76:79], a[20:23], v[172:175], v[76:79]
    buffer_load_dwordx4 v[220:223], v9, s[44:47], s86 offen offset:1536 sc1
    s_waitcnt lgkmcnt(4)
    v_mfma_f32_16x16x32_bf16 v[52:55], a[24:27], v[168:171], v[52:55]
    ds_read_b128 a[4:7], v8 offset:41984
    v_mfma_f32_16x16x32_bf16 v[80:83], a[24:27], v[172:175], v[80:83]
    buffer_load_dwordx4 v[224:227], v9, s[44:47], s86 offen offset:2048 sc1
    s_waitcnt lgkmcnt(4)
    v_mfma_f32_16x16x32_bf16 v[56:59], a[28:31], v[168:171], v[56:59]
    ds_read_b128 a[8:11], v8 offset:43008
    v_mfma_f32_16x16x32_bf16 v[84:87], a[28:31], v[172:175], v[84:87]
    s_waitcnt vmcnt(11)
    v_swap_b32 v178, v180
    s_waitcnt lgkmcnt(4)
    v_mfma_f32_16x16x32_bf16 v[60:63], a[32:35], v[168:171], v[60:63]
    ds_read_b128 a[12:15], v8 offset:44032
    v_mfma_f32_16x16x32_bf16 v[88:91], a[32:35], v[172:175], v[88:91]
    v_swap_b32 v179, v181
    s_waitcnt lgkmcnt(4)
    v_mfma_f32_16x16x32_bf16 v[64:67], a[36:39], v[168:171], v[64:67]
    ds_read_b128 a[16:19], v8 offset:45056
    v_mfma_f32_16x16x32_bf16 v[92:95], a[36:39], v[172:175], v[92:95]
    buffer_load_dwordx4 v[228:231], v9, s[44:47], s86 offen offset:2560 sc1
    s_cbranch_vccnz L_skip_47
    v_mfma_f32_16x16x32_bf16 v[104:107], v[160:163], v[160:163], v[104:107]
    v_mfma_f32_16x16x32_bf16 v[108:111], v[164:167], v[164:167], v[108:111]
    v_mfma_f32_16x16x32_bf16 v[104:107], v[168:171], v[168:171], v[104:107]
    v_mfma_f32_16x16x32_bf16 v[108:111], v[172:175], v[172:175], v[108:111]
    v_mfma_f32_16x16x32_bf16 v[104:107], v[176:179], v[176:179], v[104:107]
    v_mfma_f32_16x16x32_bf16 v[108:111], v[180:183], v[180:183], v[108:111]
L_skip_47:
    s_waitcnt lgkmcnt(4)
    v_mfma_f32_16x16x32_bf16 v[48:51], a[0:3], v[176:179], v[48:51]
    ds_read_b128 a[20:23], v6 offset:0
    v_mfma_f32_16x16x32_bf16 v[76:79], a[0:3], v[180:183], v[76:79]
    buffer_load_dwordx4 v[232:235], v9, s[44:47], s86 offen offset:3072 sc1
    s_waitcnt lgkmcnt(4)
    v_mfma_f32_16x16x32_bf16 v[52:55], a[4:7], v[176:179], v[52:55]
    ds_read_b128 a[24:27], v6 offset:1024
    v_mfma_f32_16x16x32_bf16 v[80:83], a[4:7], v[180:183], v[80:83]
    buffer_load_dwordx4 v[236:239], v9, s[44:47], s86 offen offset:3584 sc1
    s_waitcnt lgkmcnt(4)
    v_mfma_f32_16x16x32_bf16 v[56:59], a[8:11], v[176:179], v[56:59]
    ds_read_b128 a[28:31], v6 offset:2048
    v_mfma_f32_16x16x32_bf16 v[84:87], a[8:11], v[180:183], v[84:87]
    s_waitcnt vmcnt(12)
    v_swap_b32 v186, v188
    s_waitcnt lgkmcnt(4)
    v_mfma_f32_16x16x32_bf16 v[60:63], a[12:15], v[176:179], v[60:63]
    ds_read_b128 a[32:35], v6 offset:3072
    v_mfma_f32_16x16x32_bf16 v[88:91], a[12:15], v[180:183], v[88:91]
    v_swap_b32 v187, v189
    s_waitcnt lgkmcnt(4)
    v_mfma_f32_16x16x32_bf16 v[64:67], a[16:19], v[176:179], v[64:67]
    ds_read_b128 a[36:39], v6 offset:4096
    v_mfma_f32_16x16x32_bf16 v[92:95], a[16:19], v[180:183], v[92:95]
    s_add_u32 s86, s86, 4096
    buffer_load_dwordx4 v[240:243], v9, s[44:47], s86 offen sc1
    s_waitcnt lgkmcnt(4)
    v_mfma_f32_16x16x32_bf16 v[48:51], a[20:23], v[184:187], v[48:51]
    ds_read_b128 a[0:3], v6 offset:5120
    v_mfma_f32_16x16x32_bf16 v[76:79], a[20:23], v[188:191], v[76:79]
    buffer_load_dwordx4 v[244:247], v9, s[44:47], s86 offen offset:512 sc1
    s_waitcnt lgkmcnt(4)
    v_mfma_f32_16x16x32_bf16 v[52:55], a[24:27], v[184:187], v[52:55]
    ds_read_b128 a[4:7], v6 offset:6144
    v_mfma_f32_16x16x32_bf16 v[80:83], a[24:27], v[188:191], v[80:83]
    buffer_load_dwordx4 v[248:251], v9, s[44:47], s86 offen offset:1024 sc1
    s_waitcnt lgkmcnt(4)
    v_mfma_f32_16x16x32_bf16 v[56:59], a[28:31], v[184:187], v[56:59]
    ds_read_b128 a[8:11], v6 offset:7168
    v_mfma_f32_16x16x32_bf16 v[84:87], a[28:31], v[188:191], v[84:87]
    s_waitcnt vmcnt(13)
    v_swap_b32 v194, v196
    s_waitcnt lgkmcnt(4)
    v_mfma_f32_16x16x32_bf16 v[60:63], a[32:35], v[184:187], v[60:63]
    ds_read_b128 a[12:15], v6 offset:8192
    v_mfma_f32_16x16x32_bf16 v[88:91], a[32:35], v[188:191], v[88:91]
    v_swap_b32 v195, v197
    s_waitcnt lgkmcnt(4)
    v_mfma_f32_16x16x32_bf16 v[64:67], a[36:39], v[184:187], v[64:67]
    ds_read_b128 a[16:19], v6 offset:9216
    v_mfma_f32_16x16x32_bf16 v[92:95], a[36:39], v[188:191], v[92:95]
    s_waitcnt lgkmcnt(4)
    v_mfma_f32_16x16x32_bf16 v[48:51], a[0:3], v[192:195], v[48:51]
    ds_read_b128 a[20:23], v6 offset:10240
    v_mfma_f32_16x16x32_bf16 v[76:79], a[0:3], v[196:199], v[76:79]
    buffer_load_dwordx4 v[252:255], v9, s[44:47], s86 offen offset:1536 sc1
    s_waitcnt lgkmcnt(4)
    v_mfma_f32_16x16x32_bf16 v[52:55], a[4:7], v[192:195], v[52:55]
    ds_read_b128 a[24:27], v6 offset:11264
    v_mfma_f32_16x16x32_bf16 v[80:83], a[4:7], v[196:199], v[80:83]
    buffer_load_dword v44, v41, s[44:47], 0 offen offset:0 sc1
    s_waitcnt lgkmcnt(4)
    v_mfma_f32_16x16x32_bf16 v[56:59], a[8:11], v[192:195], v[56:59]
    ds_read_b128 a[28:31], v6 offset:12288
    v_mfma_f32_16x16x32_bf16 v[84:87], a[8:11], v[196:199], v[84:87]
    s_waitcnt vmcnt(13)
    v_swap_b32 v202, v204
    s_waitcnt lgkmcnt(4)
    v_mfma_f32_16x16x32_bf16 v[60:63], a[12:15], v[192:195], v[60:63]
    ds_read_b128 a[32:35], v6 offset:13312
    v_mfma_f32_16x16x32_bf16 v[88:91], a[12:15], v[196:199], v[88:91]
    v_swap_b32 v203, v205
    s_waitcnt lgkmcnt(4)
    v_mfma_f32_16x16x32_bf16 v[64:67], a[16:19], v[192:195], v[64:67]
    ds_read_b128 a[36:39], v6 offset:14336
    v_mfma_f32_16x16x32_bf16 v[92:95], a[16:19], v[196:199], v[92:95]
    s_cbranch_vccnz L_skip_48
    v_mfma_f32_16x16x32_bf16 v[104:107], v[184:187], v[184:187], v[104:107]
    v_mfma_f32_16x16x32_bf16 v[108:111], v[188:191], v[188:191], v[108:111]
    v_mfma_f32_16x16x32_bf16 v[104:107], v[192:195], v[192:195], v[104:107]
    v_mfma_f32_16x16x32_bf16 v[108:111], v[196:199], v[196:199], v[108:111]
    v_mfma_f32_16x16x32_bf16 v[104:107], v[200:203], v[200:203], v[104:107]
    v_mfma_f32_16x16x32_bf16 v[108:111], v[204:207], v[204:207], v[108:111]
L_skip_48:
    s_waitcnt lgkmcnt(4)
    v_mfma_f32_16x16x32_bf16 v[48:51], a[20:23], v[200:203], v[48:51]
    ds_read_b128 a[0:3], v6 offset:15360
    v_mfma_f32_16x16x32_bf16 v[76:79], a[20:23], v[204:207], v[76:79]
    buffer_load_dword v45, v41, s[44:47], 0 offen offset:256 sc1
    s_waitcnt lgkmcnt(4)
    v_mfma_f32_16x16x32_bf16 v[52:55], a[24:27], v[200:203], v[52:55]
    ds_read_b128 a[4:7], v6 offset:16384
    v_mfma_f32_16x16x32_bf16 v[80:83], a[24:27], v[204:207], v[80:83]
    buffer_load_dword v46, v41, s[44:47], 0 offen offset:32 sc1
    s_waitcnt lgkmcnt(4)
    v_mfma_f32_16x16x32_bf16 v[56:59], a[28:31], v[200:203], v[56:59]
    ds_read_b128 a[8:11], v6 offset:17408
    v_mfma_f32_16x16x32_bf16 v[84:87], a[28:31], v[204:207], v[84:87]
    s_waitcnt vmcnt(13)
    v_swap_b32 v210, v212
    s_waitcnt lgkmcnt(4)
    v_mfma_f32_16x16x32_bf16 v[60:63], a[32:35], v[200:203], v[60:63]
    ds_read_b128 a[12:15], v6 offset:18432
    v_mfma_f32_16x16x32_bf16 v[88:91], a[32:35], v[204:207], v[88:91]
    v_swap_b32 v211, v213
    s_waitcnt lgkmcnt(4)
    v_mfma_f32_16x16x32_bf16 v[64:67], a[36:39], v[200:203], v[64:67]
    ds_read_b128 a[16:19], v6 offset:19456
    v_mfma_f32_16x16x32_bf16 v[92:95], a[36:39], v[204:207], v[92:95]
    s_waitcnt lgkmcnt(4)
    v_mfma_f32_16x16x32_bf16 v[48:51], a[0:3], v[208:211], v[48:51]
    ds_read_b128 a[20:23], v6 offset:20480
    v_mfma_f32_16x16x32_bf16 v[76:79], a[0:3], v[212:215], v[76:79]
    buffer_load_dword v47, v41, s[44:47], 0 offen offset:288 sc1
    s_waitcnt lgkmcnt(4)
    v_mfma_f32_16x16x32_bf16 v[52:55], a[4:7], v[208:211], v[52:55]
    ds_read_b128 a[24:27], v6 offset:21504
    v_mfma_f32_16x16x32_bf16 v[80:83], a[4:7], v[212:215], v[80:83]
    buffer_load_dwordx4 v[20:23], v40, s[44:47], s6 offen offset:0 sc1
    s_waitcnt lgkmcnt(4)
    v_mfma_f32_16x16x32_bf16 v[56:59], a[8:11], v[208:211], v[56:59]
    ds_read_b128 a[28:31], v6 offset:22528
    v_mfma_f32_16x16x32_bf16 v[84:87], a[8:11], v[212:215], v[84:87]
    s_waitcnt vmcnt(13)
    v_swap_b32 v218, v220
    s_waitcnt lgkmcnt(4)
    v_mfma_f32_16x16x32_bf16 v[60:63], a[12:15], v[208:211], v[60:63]
    ds_read_b128 a[32:35], v6 offset:23552
    v_mfma_f32_16x16x32_bf16 v[88:91], a[12:15], v[212:215], v[88:91]
    v_swap_b32 v219, v221
    s_waitcnt lgkmcnt(4)
    v_mfma_f32_16x16x32_bf16 v[64:67], a[16:19], v[208:211], v[64:67]
    ds_read_b128 a[36:39], v6 offset:24576
    v_mfma_f32_16x16x32_bf16 v[92:95], a[16:19], v[212:215], v[92:95]
    s_waitcnt lgkmcnt(4)
    v_mfma_f32_16x16x32_bf16 v[48:51], a[20:23], v[216:219], v[48:51]
    ds_read_b128 a[0:3], v6 offset:25600
    v_mfma_f32_16x16x32_bf16 v[76:79], a[20:23], v[220:223], v[76:79]
    buffer_load_dwordx4 v[24:27], v40, s[44:47], s6 offen offset:64 sc1
    s_waitcnt lgkmcnt(4)
    v_mfma_f32_16x16x32_bf16 v[52:55], a[24:27], v[216:219], v[52:55]
    ds_read_b128 a[4:7], v6 offset:26624
    v_mfma_f32_16x16x32_bf16 v[80:83], a[24:27], v[220:223], v[80:83]
    buffer_load_dwordx4 v[28:31], v40, s[44:47], s6 offen offset:128 sc1
    s_waitcnt lgkmcnt(4)
    v_mfma_f32_16x16x32_bf16 v[56:59], a[28:31], v[216:219], v[56:59]
    ds_read_b128 a[8:11], v6 offset:27648
    v_mfma_f32_16x16x32_bf16 v[84:87], a[28:31], v[220:223], v[84:87]
    s_waitcnt vmcnt(13)
    v_swap_b32 v226, v228
    s_waitcnt lgkmcnt(4)
    v_mfma_f32_16x16x32_bf16 v[60:63], a[32:35], v[216:219], v[60:63]
    ds_read_b128 a[12:15], v6 offset:28672
    v_mfma_f32_16x16x32_bf16 v[88:91], a[32:35], v[220:223], v[88:91]
    v_swap_b32 v227, v229
    s_waitcnt lgkmcnt(4)
    v_mfma_f32_16x16x32_bf16 v[64:67], a[36:39], v[216:219], v[64:67]
    ds_read_b128 a[16:19], v6 offset:29696
    v_mfma_f32_16x16x32_bf16 v[92:95], a[36:39], v[220:223], v[92:95]
    s_cbranch_vccnz L_skip_49
    v_mfma_f32_16x16x32_bf16 v[104:107], v[208:211], v[208:211], v[104:107]
    v_mfma_f32_16x16x32_bf16 v[108:111], v[212:215], v[212:215], v[108:111]
    v_mfma_f32_16x16x32_bf16 v[104:107], v[216:219], v[216:219], v[104:107]
    v_mfma_f32_16x16x32_bf16 v[108:111], v[220:223], v[220:223], v[108:111]
    v_mfma_f32_16x16x32_bf16 v[104:107], v[224:227], v[224:227], v[104:107]
    v_mfma_f32_16x16x32_bf16 v[108:111], v[228:231], v[228:231], v[108:111]
L_skip_49:
    s_waitcnt lgkmcnt(4)
    v_mfma_f32_16x16x32_bf16 v[48:51], a[0:3], v[224:227], v[48:51]
    ds_read_b128 a[20:23], v6 offset:30720
    v_mfma_f32_16x16x32_bf16 v[76:79], a[0:3], v[228:231], v[76:79]
    buffer_load_dwordx2 a[240:241], v42, s[44:47], s87 offen offset:0 sc1
    s_waitcnt lgkmcnt(4)
    v_mfma_f32_16x16x32_bf16 v[52:55], a[4:7], v[224:227], v[52:55]
    ds_read_b128 a[24:27], v6 offset:31744
    v_mfma_f32_16x16x32_bf16 v[80:83], a[4:7], v[228:231], v[80:83]
    buffer_load_dwordx2 a[242:243], v42, s[44:47], s87 offen offset:512 sc1
    s_waitcnt lgkmcnt(4)
    v_mfma_f32_16x16x32_bf16 v[56:59], a[8:11], v[224:227], v[56:59]
    ds_read_b128 a[28:31], v6 offset:32768
    v_mfma_f32_16x16x32_bf16 v[84:87], a[8:11], v[228:231], v[84:87]
    s_waitcnt vmcnt(13)
    v_swap_b32 v234, v236
    s_waitcnt lgkmcnt(4)
    v_mfma_f32_16x16x32_bf16 v[60:63], a[12:15], v[224:227], v[60:63]
    ds_read_b128 a[32:35], v6 offset:33792
    v_mfma_f32_16x16x32_bf16 v[88:91], a[12:15], v[228:231], v[88:91]
    v_swap_b32 v235, v237
    s_waitcnt lgkmcnt(4)
    v_mfma_f32_16x16x32_bf16 v[64:67], a[16:19], v[224:227], v[64:67]
    ds_read_b128 a[36:39], v6 offset:34816
    v_mfma_f32_16x16x32_bf16 v[92:95], a[16:19], v[228:231], v[92:95]
    s_waitcnt lgkmcnt(4)
    v_mfma_f32_16x16x32_bf16 v[48:51], a[20:23], v[232:235], v[48:51]
    ds_read_b128 a[0:3], v6 offset:35840
    v_mfma_f32_16x16x32_bf16 v[76:79], a[20:23], v[236:239], v[76:79]
    buffer_load_dwordx2 a[244:245], v42, s[44:47], s87 offen offset:1024 sc1
    s_waitcnt lgkmcnt(4)
    v_mfma_f32_16x16x32_bf16 v[52:55], a[24:27], v[232:235], v[52:55]
    ds_read_b128 a[4:7], v6 offset:36864
    v_mfma_f32_16x16x32_bf16 v[80:83], a[24:27], v[236:239], v[80:83]
    buffer_load_dwordx2 a[246:247], v42, s[44:47], s87 offen offset:1536 sc1
    s_waitcnt lgkmcnt(4)
    v_mfma_f32_16x16x32_bf16 v[56:59], a[28:31], v[232:235], v[56:59]
    ds_read_b128 a[8:11], v6 offset:37888
    v_mfma_f32_16x16x32_bf16 v[84:87], a[28:31], v[236:239], v[84:87]
    s_waitcnt vmcnt(13)
    v_swap_b32 v242, v244
    s_waitcnt lgkmcnt(4)
    v_mfma_f32_16x16x32_bf16 v[60:63], a[32:35], v[232:235], v[60:63]
    ds_read_b128 a[12:15], v6 offset:38912
    v_mfma_f32_16x16x32_bf16 v[88:91], a[32:35], v[236:239], v[88:91]
    v_swap_b32 v243, v245
    s_waitcnt lgkmcnt(4)
    v_mfma_f32_16x16x32_bf16 v[64:67], a[36:39], v[232:235], v[64:67]
    ds_read_b128 a[16:19], v6 offset:39936
    v_mfma_f32_16x16x32_bf16 v[92:95], a[36:39], v[236:239], v[92:95]
    s_waitcnt lgkmcnt(4)
    v_mfma_f32_16x16x32_bf16 v[48:51], a[0:3], v[240:243], v[48:51]
    ds_read_b128 a[36:39], v6 offset:45056
    v_mfma_f32_16x16x32_bf16 v[76:79], a[0:3], v[244:247], v[76:79]
    buffer_load_dwordx2 a[248:249], v42, s[44:47], s87 offen offset:2048 sc1
    s_waitcnt lgkmcnt(4)
    v_mfma_f32_16x16x32_bf16 v[52:55], a[4:7], v[240:243], v[52:55]
    ds_read_b128 a[20:23], v6 offset:40960
    v_mfma_f32_16x16x32_bf16 v[80:83], a[4:7], v[244:247], v[80:83]
    s_waitcnt lgkmcnt(4)
    v_mfma_f32_16x16x32_bf16 v[56:59], a[8:11], v[240:243], v[56:59]
    ds_read_b128 a[24:27], v6 offset:41984
    v_mfma_f32_16x16x32_bf16 v[84:87], a[8:11], v[244:247], v[84:87]
    s_waitcnt vmcnt(12)
    v_swap_b32 v250, v252
    s_waitcnt lgkmcnt(4)
    v_mfma_f32_16x16x32_bf16 v[60:63], a[12:15], v[240:243], v[60:63]
    ds_read_b128 a[28:31], v6 offset:43008
    v_mfma_f32_16x16x32_bf16 v[88:91], a[12:15], v[244:247], v[88:91]
    v_swap_b32 v251, v253
    s_waitcnt lgkmcnt(4)
    v_mfma_f32_16x16x32_bf16 v[64:67], a[16:19], v[240:243], v[64:67]
    ds_read_b128 a[32:35], v6 offset:44032
    v_mfma_f32_16x16x32_bf16 v[92:95], a[16:19], v[244:247], v[92:95]
    s_cbranch_vccnz L_skip_50
    v_mfma_f32_16x16x32_bf16 v[104:107], v[232:235], v[232:235], v[104:107]
    v_mfma_f32_16x16x32_bf16 v[108:111], v[236:239], v[236:239], v[108:111]
    v_mfma_f32_16x16x32_bf16 v[104:107], v[240:243], v[240:243], v[104:107]
    v_mfma_f32_16x16x32_bf16 v[108:111], v[244:247], v[244:247], v[108:111]
    v_mfma_f32_16x16x32_bf16 v[104:107], v[248:251], v[248:251], v[104:107]
    v_mfma_f32_16x16x32_bf16 v[108:111], v[252:255], v[252:255], v[108:111]
L_skip_50:
    s_cbranch_vccz L_skip_51
    s_waitcnt vmcnt(10)
    s_nop 4
    v_add_f32 v104, v44, v45
    s_waitcnt vmcnt(8)
    v_add_f32 v108, v46, v47
    v_mov_b32 v105, v104
    v_mov_b32 v106, v104
    v_mov_b32 v107, v104
    v_mov_b32 v109, v108
    v_mov_b32 v110, v108
    v_mov_b32 v111, v108
L_skip_51:
    s_waitcnt lgkmcnt(4)
    v_mfma_f32_16x16x32_bf16 v[64:67], a[36:39], v[248:251], v[64:67]
    v_mfma_f32_16x16x32_bf16 v[92:95], a[36:39], v[252:255], v[92:95]
    s_waitcnt lgkmcnt(3)
    v_mfma_f32_16x16x32_bf16 v[48:51], a[20:23], v[248:251], v[48:51]
    s_lshl_b64 vcc, s[80:81], 0
    v_cndmask_b32 v16, 0, v104, vcc
    v_mfma_f32_16x16x32_bf16 v[76:79], a[20:23], v[252:255], v[76:79]
    v_cndmask_b32 v17, 0, v108, vcc
    s_lshl_b64 vcc, s[80:81], 1
    s_waitcnt lgkmcnt(2)
    v_mfma_f32_16x16x32_bf16 v[52:55], a[24:27], v[248:251], v[52:55]
    v_cndmask_b32 v16, v16, v105, vcc
    v_cndmask_b32 v17, v17, v109, vcc
    v_mfma_f32_16x16x32_bf16 v[80:83], a[24:27], v[252:255], v[80:83]
    s_lshl_b64 vcc, s[80:81], 2
    v_cndmask_b32 v16, v16, v106, vcc
    s_waitcnt lgkmcnt(1)
    v_mfma_f32_16x16x32_bf16 v[56:59], a[28:31], v[248:251], v[56:59]
    v_cndmask_b32 v17, v17, v110, vcc
    s_lshl_b64 vcc, s[80:81], 3
    v_mfma_f32_16x16x32_bf16 v[84:87], a[28:31], v[252:255], v[84:87]
    v_cndmask_b32 v16, v16, v107, vcc
    v_cndmask_b32 v17, v17, v111, vcc
    s_waitcnt lgkmcnt(0)
    v_mfma_f32_16x16x32_bf16 v[60:63], a[32:35], v[248:251], v[60:63]
    v_nop
    v_permlane16_swap_b32 v16, v17
    v_mfma_f32_16x16x32_bf16 v[88:91], a[32:35], v[252:255], v[88:91]
    v_add_f32 v16, v16, v17
    v_mov_b32 v17, v16
    v_nop
    s_nop 0
    v_permlane32_swap_b32 v16, v17
    v_add_f32 v16, v16, v17
    v_mov_b32 v17, v16
    s_nop 1
    v_permlane16_swap_b32 v16, v17
    v_mul_f32 v66, 0x3ae38e39, v66
    v_mul_f32 v16, 0x3ae38e39, v16
    v_mul_f32 v94, 0x3ae38e39, v94
    v_mul_f32 v17, 0x3ae38e39, v17
    v_fma_f32 v16, -v66, v66, v16
    v_fma_f32 v17, -v94, v94, v17
    s_waitcnt vmcnt(7)
    v_pk_fma_f32 v[56:57], v[20:21], v[66:67], v[56:57] op_sel_hi:[1,0,1] neg_lo:[1,0,0] neg_hi:[1,0,0]
    v_pk_fma_f32 v[84:85], v[20:21], v[94:95], v[84:85] op_sel_hi:[1,0,1] neg_lo:[1,0,0] neg_hi:[1,0,0]
    v_pk_fma_f32 v[58:59], v[22:23], v[66:67], v[58:59] op_sel_hi:[1,0,1] neg_lo:[1,0,0] neg_hi:[1,0,0]
    v_pk_fma_f32 v[86:87], v[22:23], v[94:95], v[86:87] op_sel_hi:[1,0,1] neg_lo:[1,0,0] neg_hi:[1,0,0]
    s_waitcnt vmcnt(6)
    v_pk_fma_f32 v[60:61], v[24:25], v[66:67], v[60:61] op_sel_hi:[1,0,1] neg_lo:[1,0,0] neg_hi:[1,0,0]
    v_pk_fma_f32 v[88:89], v[24:25], v[94:95], v[88:89] op_sel_hi:[1,0,1] neg_lo:[1,0,0] neg_hi:[1,0,0]
    v_pk_fma_f32 v[62:63], v[26:27], v[66:67], v[62:63] op_sel_hi:[1,0,1] neg_lo:[1,0,0] neg_hi:[1,0,0]
    v_pk_fma_f32 v[90:91], v[26:27], v[94:95], v[90:91] op_sel_hi:[1,0,1] neg_lo:[1,0,0] neg_hi:[1,0,0]
    s_waitcnt vmcnt(5)
    v_pk_fma_f32 v[64:65], v[28:29], v[66:67], v[64:65] op_sel_hi:[1,0,1] neg_lo:[1,0,0] neg_hi:[1,0,0]
    v_pk_fma_f32 v[92:93], v[28:29], v[94:95], v[92:93] op_sel_hi:[1,0,1] neg_lo:[1,0,0] neg_hi:[1,0,0]
    v_max_f32 v16, 0, v16
    v_max_f32 v17, 0, v17
    v_add_f32 v16, 0x3727c5ac, v16
    v_add_f32 v17, 0x3727c5ac, v17
    v_rsq_f32 v12, v16
    v_rsq_f32 v14, v17
    v_mul_f32 v8, 0x3fb8aa3b, v12
    v_mul_f32 v10, 0x3fb8aa3b, v14
    v_accvgpr_read_b32 v6, a200
    v_lshlrev_b32 v16, 4, v3
    v_sub_u32 v17, v6, v16
    v_mul_f32 v57, v12, v57
    v_pk_mul_f32 v[58:59], v[58:59], v[12:13] op_sel_hi:[1,0]
    v_pk_mul_f32 v[60:61], v[60:61], v[12:13] op_sel_hi:[1,0]
    v_pk_mul_f32 v[62:63], v[62:63], v[12:13] op_sel_hi:[1,0]
    v_pk_mul_f32 v[64:65], v[64:65], v[12:13] op_sel_hi:[1,0]
    v_cvt_pk_bf16_f32 v104, v57, v58
    v_cvt_pk_bf16_f32 v105, v59, v60
    v_cvt_pk_bf16_f32 v106, v61, v62
    v_cvt_pk_bf16_f32 v107, v63, v64
    v_cvt_pk_bf16_f32 v66, v65, 1.0
    ds_write_b64 v17, v[104:105] offset:160
    ds_write_b64 v17, v[106:107] offset:168
    ds_write_b32 v17, v66 offset:176
    v_mul_f32 v85, v14, v85
    v_pk_mul_f32 v[86:87], v[86:87], v[14:15] op_sel_hi:[1,0]
    v_pk_mul_f32 v[88:89], v[88:89], v[14:15] op_sel_hi:[1,0]
    v_pk_mul_f32 v[90:91], v[90:91], v[14:15] op_sel_hi:[1,0]
    v_pk_mul_f32 v[92:93], v[92:93], v[14:15] op_sel_hi:[1,0]
    v_cvt_pk_bf16_f32 v108, v85, v86
    v_cvt_pk_bf16_f32 v109, v87, v88
    v_cvt_pk_bf16_f32 v110, v89, v90
    v_cvt_pk_bf16_f32 v111, v91, v92
    v_cvt_pk_bf16_f32 v94, v93, 1.0
    ds_write_b64 v17, v[108:109] offset:4384
    ds_write_b64 v17, v[110:111] offset:4392
    ds_write_b32 v17, v94 offset:4400
    v_max3_f32 v26, v48, v49, v50
    v_max3_f32 v27, -v48, -v49, -v50
    v_max3_f32 v42, v76, v77, v78
    v_max3_f32 v43, -v76, -v77, -v78
    v_max3_f32 v26, v26, v51, v52
    v_max3_f32 v27, v27, -v51, -v52
    v_max3_f32 v42, v42, v79, v80
    v_max3_f32 v43, v43, -v79, -v80
    v_max3_f32 v26, v26, v53, v54
    v_max3_f32 v27, v27, -v53, -v54
    v_max3_f32 v42, v42, v81, v82
    v_max3_f32 v43, v43, -v81, -v82
    v_max3_f32 v26, v26, v55, v56
    v_max3_f32 v27, v27, -v55, -v56
    v_max3_f32 v42, v42, v83, v84
    v_max3_f32 v43, v43, -v83, -v84
    v_permlane16_swap_b32 v26, v27
    s_nop 0
    v_permlane16_swap_b32 v42, v43
    v_max_f32 v26, v26, v27
    v_max_f32 v42, v42, v43
    v_mul_f32 v26, v8, v26
    v_mul_f32 v42, v10, v42
    v_mov_b32 v27, v26
    v_mov_b32 v43, v42
    s_nop 0
    v_permlane16_swap_b32 v26, v27
    v_permlane16_swap_b32 v42, v43
    v_pk_fma_f32 v[16:17], v[48:49], v[8:9], v[26:27] op_sel:[0,0,1] op_sel_hi:[1,0,1] neg_lo:[1,0,1] neg_hi:[1,0,1]
    v_pk_fma_f32 v[48:49], v[48:49], v[8:9], v[26:27] op_sel_hi:[1,0,0] neg_lo:[0,0,1] neg_hi:[0,0,1]
    v_pk_fma_f32 v[32:33], v[76:77], v[10:11], v[42:43] op_sel:[0,0,1] op_sel_hi:[1,0,1] neg_lo:[1,0,1] neg_hi:[1,0,1]
    v_pk_fma_f32 v[76:77], v[76:77], v[10:11], v[42:43] op_sel_hi:[1,0,0] neg_lo:[0,0,1] neg_hi:[0,0,1]
    v_pk_fma_f32 v[18:19], v[50:51], v[8:9], v[26:27] op_sel:[0,0,1] op_sel_hi:[1,0,1] neg_lo:[1,0,1] neg_hi:[1,0,1]
    v_pk_fma_f32 v[50:51], v[50:51], v[8:9], v[26:27] op_sel_hi:[1,0,0] neg_lo:[0,0,1] neg_hi:[0,0,1]
    v_pk_fma_f32 v[34:35], v[78:79], v[10:11], v[42:43] op_sel:[0,0,1] op_sel_hi:[1,0,1] neg_lo:[1,0,1] neg_hi:[1,0,1]
    v_pk_fma_f32 v[78:79], v[78:79], v[10:11], v[42:43] op_sel_hi:[1,0,0] neg_lo:[0,0,1] neg_hi:[0,0,1]
    v_pk_fma_f32 v[20:21], v[52:53], v[8:9], v[26:27] op_sel:[0,0,1] op_sel_hi:[1,0,1] neg_lo:[1,0,1] neg_hi:[1,0,1]
    v_pk_fma_f32 v[52:53], v[52:53], v[8:9], v[26:27] op_sel_hi:[1,0,0] neg_lo:[0,0,1] neg_hi:[0,0,1]
    v_pk_fma_f32 v[36:37], v[80:81], v[10:11], v[42:43] op_sel:[0,0,1] op_sel_hi:[1,0,1] neg_lo:[1,0,1] neg_hi:[1,0,1]
    v_pk_fma_f32 v[80:81], v[80:81], v[10:11], v[42:43] op_sel_hi:[1,0,0] neg_lo:[0,0,1] neg_hi:[0,0,1]
    v_pk_fma_f32 v[22:23], v[54:55], v[8:9], v[26:27] op_sel:[0,0,1] op_sel_hi:[1,0,1] neg_lo:[1,0,1] neg_hi:[1,0,1]
    v_pk_fma_f32 v[54:55], v[54:55], v[8:9], v[26:27] op_sel_hi:[1,0,0] neg_lo:[0,0,1] neg_hi:[0,0,1]
    v_pk_fma_f32 v[38:39], v[82:83], v[10:11], v[42:43] op_sel:[0,0,1] op_sel_hi:[1,0,1] neg_lo:[1,0,1] neg_hi:[1,0,1]
    v_pk_fma_f32 v[82:83], v[82:83], v[10:11], v[42:43] op_sel_hi:[1,0,0] neg_lo:[0,0,1] neg_hi:[0,0,1]
    v_fma_f32 v24, v56, v8, -v26
    v_fma_f32 v25, -v56, v8, -v27
    v_fma_f32 v40, v84, v10, -v42
    v_fma_f32 v41, -v84, v10, -v43
    v_exp_f32 v48, v48
    v_exp_f32 v16, v16
    v_exp_f32 v49, v49
    v_exp_f32 v17, v17
    v_exp_f32 v50, v50
    v_exp_f32 v18, v18
    v_exp_f32 v51, v51
    v_exp_f32 v19, v19
    v_exp_f32 v52, v52
    v_exp_f32 v20, v20
    v_exp_f32 v53, v53
    v_exp_f32 v21, v21
    v_exp_f32 v54, v54
    v_exp_f32 v22, v22
    v_exp_f32 v55, v55
    v_exp_f32 v23, v23
    v_exp_f32 v24, v24
    v_exp_f32 v25, v25
    v_exp_f32 v76, v76
    v_exp_f32 v32, v32
    v_exp_f32 v77, v77
    v_exp_f32 v33, v33
    v_exp_f32 v78, v78
    v_exp_f32 v34, v34
    v_exp_f32 v79, v79
    v_exp_f32 v35, v35
    v_exp_f32 v80, v80
    v_exp_f32 v36, v36
    v_exp_f32 v81, v81
    v_exp_f32 v37, v37
    v_exp_f32 v82, v82
    v_exp_f32 v38, v38
    v_exp_f32 v83, v83
    v_exp_f32 v39, v39
    v_exp_f32 v40, v40
    v_exp_f32 v41, v41
    v_pk_add_f32 v[28:29], v[48:49], v[50:51]
    v_pk_add_f32 v[30:31], v[16:17], v[18:19]
    v_pk_add_f32 v[44:45], v[76:77], v[78:79]
    v_pk_add_f32 v[46:47], v[32:33], v[34:35]
    v_pk_add_f32 v[28:29], v[28:29], v[52:53]
    v_pk_add_f32 v[30:31], v[30:31], v[20:21]
    v_pk_add_f32 v[44:45], v[44:45], v[80:81]
    v_pk_add_f32 v[46:47], v[46:47], v[36:37]
    v_pk_add_f32 v[28:29], v[28:29], v[54:55]
    v_pk_add_f32 v[30:31], v[30:31], v[22:23]
    v_pk_add_f32 v[44:45], v[44:45], v[82:83]
    v_pk_add_f32 v[46:47], v[46:47], v[38:39]
    v_add_f32 v26, v28, v29
    v_add_f32 v27, v30, v31
    v_add_f32 v42, v44, v45
    v_add_f32 v43, v46, v47
    v_pk_add_f32 v[26:27], v[26:27], v[24:25]
    v_pk_add_f32 v[42:43], v[42:43], v[40:41]
    s_nop 0
    v_permlane16_swap_b32 v26, v27
    v_permlane16_swap_b32 v42, v43
    v_add_f32 v26, v26, v27
    v_add_f32 v42, v42, v43
    v_rcp_f32 v26, v26
    v_rcp_f32 v42, v42
    v_mov_b32 v27, v26
    v_mov_b32 v43, v42
    s_nop 0
    v_permlane16_swap_b32 v26, v27
    v_permlane16_swap_b32 v42, v43
    v_pk_mul_f32 v[48:49], v[48:49], v[26:27] op_sel_hi:[1,0]
    v_pk_mul_f32 v[16:17], v[16:17], v[26:27] op_sel:[0,1] op_sel_hi:[1,1]
    v_pk_mul_f32 v[76:77], v[76:77], v[42:43] op_sel_hi:[1,0]
    v_pk_mul_f32 v[32:33], v[32:33], v[42:43] op_sel:[0,1] op_sel_hi:[1,1]
    v_pk_mul_f32 v[50:51], v[50:51], v[26:27] op_sel_hi:[1,0]
    v_pk_mul_f32 v[18:19], v[18:19], v[26:27] op_sel:[0,1] op_sel_hi:[1,1]
    v_pk_mul_f32 v[78:79], v[78:79], v[42:43] op_sel_hi:[1,0]
    v_pk_mul_f32 v[34:35], v[34:35], v[42:43] op_sel:[0,1] op_sel_hi:[1,1]
    v_pk_mul_f32 v[52:53], v[52:53], v[26:27] op_sel_hi:[1,0]
    v_pk_mul_f32 v[20:21], v[20:21], v[26:27] op_sel:[0,1] op_sel_hi:[1,1]
    v_pk_mul_f32 v[80:81], v[80:81], v[42:43] op_sel_hi:[1,0]
    v_pk_mul_f32 v[36:37], v[36:37], v[42:43] op_sel:[0,1] op_sel_hi:[1,1]
    v_pk_mul_f32 v[54:55], v[54:55], v[26:27] op_sel_hi:[1,0]
    v_pk_mul_f32 v[22:23], v[22:23], v[26:27] op_sel:[0,1] op_sel_hi:[1,1]
    v_pk_mul_f32 v[82:83], v[82:83], v[42:43] op_sel_hi:[1,0]
    v_pk_mul_f32 v[38:39], v[38:39], v[42:43] op_sel:[0,1] op_sel_hi:[1,1]
    v_pk_mul_f32 v[24:25], v[24:25], v[26:27]
    v_pk_mul_f32 v[40:41], v[40:41], v[42:43]
    v_cvt_pk_bf16_f32 v58, v48, v49
    v_cvt_pk_bf16_f32 v59, v50, v51
    v_cvt_pk_bf16_f32 v60, v52, v53
    v_cvt_pk_bf16_f32 v61, v54, v55
    v_cvt_pk_bf16_f32 v62, v24, v16
    v_cvt_pk_bf16_f32 v63, v17, v18
    v_cvt_pk_bf16_f32 v64, v19, v20
    v_cvt_pk_bf16_f32 v65, v21, v22
    v_cvt_pk_bf16_f32 v66, v23, v25
    v_cvt_pk_bf16_f32 v86, v76, v77
    v_cvt_pk_bf16_f32 v87, v78, v79
    v_cvt_pk_bf16_f32 v88, v80, v81
    v_cvt_pk_bf16_f32 v89, v82, v83
    v_cvt_pk_bf16_f32 v90, v40, v32
    v_cvt_pk_bf16_f32 v91, v33, v34
    v_cvt_pk_bf16_f32 v92, v35, v36
    v_cvt_pk_bf16_f32 v93, v37, v38
    v_cvt_pk_bf16_f32 v94, v39, v41
    ds_write_b64 v6, v[58:59] offset:0
    ds_write_b64 v6, v[60:61] offset:8
    ds_write_b64 v6, v[62:63] offset:16
    ds_write_b64 v6, v[64:65] offset:24
    ds_write_b32 v6, v66 offset:32
    ds_write_b64 v6, v[86:87] offset:4224
    ds_write_b64 v6, v[88:89] offset:4232
    ds_write_b64 v6, v[90:91] offset:4240
    ds_write_b64 v6, v[92:93] offset:4248
    ds_write_b32 v6, v94 offset:4256
    v_accvgpr_read_b32 v16, a201
    v_accvgpr_read_b32 v17, a202
    v_accvgpr_read_b32 v18, a203
    v_accvgpr_read_b32 v19, a204
    s_waitcnt vmcnt(0)
    s_waitcnt lgkmcnt(0)
    s_barrier
    ds_read_b64_tr_b16 a[72:73], v19 offset:0
    ds_read_b64_tr_b16 a[74:75], v19 offset:264
    ds_read_b64_tr_b16 a[76:77], v16 offset:0
    ds_read_b64_tr_b16 a[78:79], v16 offset:264
    ds_read_b64_tr_b16 a[80:81], v17 offset:0
    ds_read_b64_tr_b16 a[82:83], v17 offset:264
    ds_read_b64_tr_b16 a[84:85], v18 offset:0
    ds_read_b64_tr_b16 a[86:87], v18 offset:264
    ds_read_b64_tr_b16 a[88:89], v19 offset:8448
    ds_read_b64_tr_b16 a[90:91], v19 offset:8712
    ds_read_b64_tr_b16 a[92:93], v16 offset:8448
    ds_read_b64_tr_b16 a[94:95], v16 offset:8712
    ds_read_b64_tr_b16 a[96:97], v17 offset:8448
    ds_read_b64_tr_b16 a[98:99], v17 offset:8712
    ds_read_b64_tr_b16 a[100:101], v18 offset:8448
    ds_read_b64_tr_b16 a[102:103], v18 offset:8712
    s_waitcnt lgkmcnt(12)
    v_mfma_f32_16x16x32_bf16 v[20:23], a[76:79], a[72:75], 0
    s_waitcnt lgkmcnt(10)
    v_mfma_f32_16x16x32_bf16 v[24:27], a[80:83], a[72:75], 0
    s_waitcnt lgkmcnt(8)
    v_mfma_f32_16x16x32_bf16 v[28:31], a[84:87], a[72:75], 0
    s_waitcnt lgkmcnt(4)
    v_mfma_f32_16x16x32_bf16 v[20:23], a[92:95], a[88:91], v[20:23]
    s_waitcnt lgkmcnt(2)
    v_mfma_f32_16x16x32_bf16 v[24:27], a[96:99], a[88:91], v[24:27]
    s_waitcnt lgkmcnt(0)
    v_mfma_f32_16x16x32_bf16 v[28:31], a[100:103], a[88:91], v[28:31]
    ds_read_b64_tr_b16 a[104:105], v19 offset:16896
    ds_read_b64_tr_b16 a[106:107], v19 offset:17160
    ds_read_b64_tr_b16 a[108:109], v16 offset:16896
    ds_read_b64_tr_b16 a[110:111], v16 offset:17160
    ds_read_b64_tr_b16 a[112:113], v17 offset:16896
    ds_read_b64_tr_b16 a[114:115], v17 offset:17160
    ds_read_b64_tr_b16 a[116:117], v18 offset:16896
    ds_read_b64_tr_b16 a[118:119], v18 offset:17160
    ds_read_b64_tr_b16 a[120:121], v19 offset:25344
    ds_read_b64_tr_b16 a[122:123], v19 offset:25608
    ds_read_b64_tr_b16 a[124:125], v16 offset:25344
    ds_read_b64_tr_b16 a[126:127], v16 offset:25608
    ds_read_b64_tr_b16 a[128:129], v17 offset:25344
    ds_read_b64_tr_b16 a[130:131], v17 offset:25608
    ds_read_b64_tr_b16 a[132:133], v18 offset:25344
    ds_read_b64_tr_b16 a[134:135], v18 offset:25608
    s_waitcnt lgkmcnt(12)
    v_mfma_f32_16x16x32_bf16 v[20:23], a[108:111], a[104:107], v[20:23]
    s_waitcnt lgkmcnt(10)
    v_mfma_f32_16x16x32_bf16 v[24:27], a[112:115], a[104:107], v[24:27]
    s_waitcnt lgkmcnt(8)
    v_mfma_f32_16x16x32_bf16 v[28:31], a[116:119], a[104:107], v[28:31]
    s_waitcnt lgkmcnt(4)
    v_mfma_f32_16x16x32_bf16 v[20:23], a[124:127], a[120:123], v[20:23]
    s_waitcnt lgkmcnt(2)
    v_mfma_f32_16x16x32_bf16 v[24:27], a[128:131], a[120:123], v[24:27]
    s_waitcnt lgkmcnt(0)
    v_mfma_f32_16x16x32_bf16 v[28:31], a[132:135], a[120:123], v[28:31]
    ds_read_b128 a[40:43], v7 offset:0
    ds_read_b128 a[44:47], v7 offset:1024
    ds_read_b128 a[48:51], v7 offset:2048
    ds_read_b128 a[52:55], v7 offset:3072
    ds_read_b128 a[56:59], v7 offset:4096
    ds_read_b128 a[60:63], v7 offset:5120
    v_accvgpr_read_b32 v40, a205
    v_accvgpr_read_b32 v41, a220
    v_mov_b32 v35, v5
    v_mov_b32 v39, v5
    s_lshl_b32 s5, s68, 12
    s_add_u32 s5, s5, s88
    v_cvt_pk_bf16_f32 v32, v20, v21
    v_cvt_pk_bf16_f32 v33, v22, v23
    v_cvt_pk_bf16_f32 v34, v24, v25
    v_cvt_pk_bf16_f32 v36, v26, v27
    v_cvt_pk_bf16_f32 v37, v28, v29
    v_cvt_pk_bf16_f32 v38, v30, v31
    s_mov_b32 exec_lo, 0x3ff03ff
    s_mov_b32 exec_hi, 0x3ff03ff
    buffer_store_dwordx4 v[32:35], v40, s[44:47], s5 offen sc1
    s_mov_b32 exec_lo, 0x3ff
    s_mov_b32 exec_hi, 0x3ff
    buffer_store_dwordx4 v[36:39], v41, s[44:47], s5 offen sc1
    s_mov_b64 exec, -1
    s_lshl_b32 s5, s69, 7
    s_add_u32 s5, s5, s15
    s_cmp_lg_u32 s3, 0
    s_cbranch_scc1 L_skip_52
    s_mov_b32 exec_lo, 0xff
    s_mov_b32 exec_hi, 0x0
    s_cmp_eq_u32 s13, 0
    s_cbranch_scc1 L_far_53
    buffer_store_dwordx4 v[2:5], v4, s[44:47], s5 offen
    s_nop 1
    s_branch L_join_54
L_far_53:
    buffer_store_dwordx4 v[2:5], v4, s[44:47], s5 offen sc1
    s_nop 1
L_join_54:
    s_mov_b64 exec, -1
L_skip_52:
    s_mul_i32 s92, s71, 82944
    s_mul_i32 s91, s3, 21504
    s_add_u32 s92, s92, s91
    s_add_u32 s92, s92, 5361664
    v_accvgpr_read_b32 v41, a206
    ds_read_b128 a[64:67], v7 offset:6144
    s_waitcnt lgkmcnt(6)
    v_mfma_f32_16x16x32_bf16 v[68:71], a[40:43], v[112:115], 0
    s_mov_b32 m0, s91
    s_nop 0
    buffer_load_dwordx4 v4, s[44:47], s92 offen sc1 lds
    v_mfma_f32_16x16x32_bf16 v[96:99], a[40:43], v[116:119], 0
    ds_read_b128 a[68:71], v7 offset:7168
    s_waitcnt lgkmcnt(6)
    v_mfma_f32_16x16x32_bf16 v[72:75], a[44:47], v[112:115], 0
    v_mfma_f32_16x16x32_bf16 v[100:103], a[44:47], v[116:119], 0
    ds_read_b128 a[40:43], v7 offset:8192
    s_waitcnt lgkmcnt(6)
    v_mfma_f32_16x16x32_bf16 v[68:71], a[48:51], v[120:123], v[68:71]
    buffer_load_dwordx4 v4, s[44:47], s92 offen offset:1024 sc1 lds
    v_mfma_f32_16x16x32_bf16 v[96:99], a[48:51], v[124:127], v[96:99]
    ds_read_b128 a[44:47], v7 offset:9216
    s_waitcnt lgkmcnt(6)
    v_mfma_f32_16x16x32_bf16 v[72:75], a[52:55], v[120:123], v[72:75]
    v_mfma_f32_16x16x32_bf16 v[100:103], a[52:55], v[124:127], v[100:103]
    ds_read_b128 a[48:51], v7 offset:10240
    s_waitcnt lgkmcnt(6)
    v_mfma_f32_16x16x32_bf16 v[68:71], a[56:59], v[128:131], v[68:71]
    buffer_load_dwordx4 v4, s[44:47], s92 offen offset:2048 sc1 lds
    v_mfma_f32_16x16x32_bf16 v[96:99], a[56:59], v[132:135], v[96:99]
    ds_read_b128 a[52:55], v7 offset:11264
    s_waitcnt lgkmcnt(6)
    v_mfma_f32_16x16x32_bf16 v[72:75], a[60:63], v[128:131], v[72:75]
    v_mfma_f32_16x16x32_bf16 v[100:103], a[60:63], v[132:135], v[100:103]
    ds_read_b128 a[56:59], v7 offset:12288
    s_waitcnt lgkmcnt(6)
    v_mfma_f32_16x16x32_bf16 v[68:71], a[64:67], v[136:139], v[68:71]
    buffer_load_dwordx4 v4, s[44:47], s92 offen offset:3072 sc1 lds
    s_add_u32 s91, s91, 4096
    s_add_u32 s92, s92, 4096
    v_mfma_f32_16x16x32_bf16 v[96:99], a[64:67], v[140:143], v[96:99]
    ds_read_b128 a[60:63], v7 offset:13312
    s_waitcnt lgkmcnt(6)
    v_mfma_f32_16x16x32_bf16 v[72:75], a[68:71], v[136:139], v[72:75]
    v_mfma_f32_16x16x32_bf16 v[100:103], a[68:71], v[140:143], v[100:103]
    ds_read_b128 a[64:67], v7 offset:14336
    s_waitcnt lgkmcnt(6)
    v_mfma_f32_16x16x32_bf16 v[68:71], a[40:43], v[144:147], v[68:71]
    s_mov_b32 m0, s91
    s_nop 0
    buffer_load_dwordx4 v4, s[44:47], s92 offen sc1 lds
    v_mfma_f32_16x16x32_bf16 v[96:99], a[40:43], v[148:151], v[96:99]
    ds_read_b128 a[68:71], v7 offset:15360
    s_waitcnt lgkmcnt(6)
    v_mfma_f32_16x16x32_bf16 v[72:75], a[44:47], v[144:147], v[72:75]
    v_mfma_f32_16x16x32_bf16 v[100:103], a[44:47], v[148:151], v[100:103]
    ds_read_b128 a[40:43], v7 offset:16384
    s_waitcnt lgkmcnt(6)
    v_mfma_f32_16x16x32_bf16 v[68:71], a[48:51], v[152:155], v[68:71]
    buffer_load_dwordx4 v4, s[44:47], s92 offen offset:1024 sc1 lds
    v_mfma_f32_16x16x32_bf16 v[96:99], a[48:51], v[156:159], v[96:99]
    ds_read_b128 a[44:47], v7 offset:17408
    s_waitcnt lgkmcnt(6)
    v_mfma_f32_16x16x32_bf16 v[72:75], a[52:55], v[152:155], v[72:75]
    v_mfma_f32_16x16x32_bf16 v[100:103], a[52:55], v[156:159], v[100:103]
    ds_read_b128 a[48:51], v7 offset:18432
    s_waitcnt lgkmcnt(6)
    v_mfma_f32_16x16x32_bf16 v[68:71], a[56:59], v[160:163], v[68:71]
    buffer_load_dwordx4 v4, s[44:47], s92 offen offset:2048 sc1 lds
    v_mfma_f32_16x16x32_bf16 v[96:99], a[56:59], v[164:167], v[96:99]
    ds_read_b128 a[52:55], v7 offset:19456
    s_waitcnt lgkmcnt(6)
    v_mfma_f32_16x16x32_bf16 v[72:75], a[60:63], v[160:163], v[72:75]
    v_mfma_f32_16x16x32_bf16 v[100:103], a[60:63], v[164:167], v[100:103]
    ds_read_b128 a[56:59], v7 offset:20480
    s_waitcnt lgkmcnt(6)
    v_mfma_f32_16x16x32_bf16 v[68:71], a[64:67], v[168:171], v[68:71]
    buffer_load_dwordx4 v4, s[44:47], s92 offen offset:3072 sc1 lds
    s_add_u32 s91, s91, 4096
    s_add_u32 s92, s92, 4096
    v_mfma_f32_16x16x32_bf16 v[96:99], a[64:67], v[172:175], v[96:99]
    ds_read_b128 a[60:63], v7 offset:21504
    s_waitcnt lgkmcnt(6)
    v_mfma_f32_16x16x32_bf16 v[72:75], a[68:71], v[168:171], v[72:75]
    v_mfma_f32_16x16x32_bf16 v[100:103], a[68:71], v[172:175], v[100:103]
    ds_read_b128 a[64:67], v7 offset:22528
    s_waitcnt lgkmcnt(6)
    v_mfma_f32_16x16x32_bf16 v[68:71], a[40:43], v[176:179], v[68:71]
    s_mov_b32 m0, s91
    s_nop 0
    buffer_load_dwordx4 v4, s[44:47], s92 offen sc1 lds
    v_mfma_f32_16x16x32_bf16 v[96:99], a[40:43], v[180:183], v[96:99]
    ds_read_b128 a[68:71], v7 offset:23552
    s_waitcnt lgkmcnt(6)
    v_mfma_f32_16x16x32_bf16 v[72:75], a[44:47], v[176:179], v[72:75]
    v_mfma_f32_16x16x32_bf16 v[100:103], a[44:47], v[180:183], v[100:103]
    ds_read_b128 a[40:43], v7 offset:24576
    s_waitcnt lgkmcnt(6)
    v_mfma_f32_16x16x32_bf16 v[68:71], a[48:51], v[184:187], v[68:71]
    buffer_load_dwordx4 v4, s[44:47], s92 offen offset:1024 sc1 lds
    v_mfma_f32_16x16x32_bf16 v[96:99], a[48:51], v[188:191], v[96:99]
    ds_read_b128 a[44:47], v7 offset:25600
    s_waitcnt lgkmcnt(6)
    v_mfma_f32_16x16x32_bf16 v[72:75], a[52:55], v[184:187], v[72:75]
    v_mfma_f32_16x16x32_bf16 v[100:103], a[52:55], v[188:191], v[100:103]
    ds_read_b128 a[48:51], v7 offset:26624
    s_waitcnt lgkmcnt(6)
    v_mfma_f32_16x16x32_bf16 v[68:71], a[56:59], v[192:195], v[68:71]
    buffer_load_dwordx4 v4, s[44:47], s92 offen offset:2048 sc1 lds
    v_mfma_f32_16x16x32_bf16 v[96:99], a[56:59], v[196:199], v[96:99]
    ds_read_b128 a[52:55], v7 offset:27648
    s_waitcnt lgkmcnt(6)
    v_mfma_f32_16x16x32_bf16 v[72:75], a[60:63], v[192:195], v[72:75]
    v_mfma_f32_16x16x32_bf16 v[100:103], a[60:63], v[196:199], v[100:103]
    buffer_load_dwordx4 v[32:35], v41, s[44:47], s88 offen sc1
    ds_read_b128 a[56:59], v7 offset:28672
    s_waitcnt lgkmcnt(6)
    v_mfma_f32_16x16x32_bf16 v[68:71], a[64:67], v[200:203], v[68:71]
    v_mfma_f32_16x16x32_bf16 v[96:99], a[64:67], v[204:207], v[96:99]
    ds_read_b128 a[60:63], v7 offset:29696
    s_waitcnt lgkmcnt(6)
    v_mfma_f32_16x16x32_bf16 v[72:75], a[68:71], v[200:203], v[72:75]
    v_mfma_f32_16x16x32_bf16 v[100:103], a[68:71], v[204:207], v[100:103]
    ds_read_b128 a[64:67], v7 offset:30720
    s_waitcnt lgkmcnt(6)
    v_mfma_f32_16x16x32_bf16 v[68:71], a[40:43], v[208:211], v[68:71]
    v_mfma_f32_16x16x32_bf16 v[96:99], a[40:43], v[212:215], v[96:99]
    ds_read_b128 a[68:71], v7 offset:31744
    s_waitcnt lgkmcnt(6)
    v_mfma_f32_16x16x32_bf16 v[72:75], a[44:47], v[208:211], v[72:75]
    v_mfma_f32_16x16x32_bf16 v[100:103], a[44:47], v[212:215], v[100:103]
    ds_read_b128 a[40:43], v7 offset:32768
    s_waitcnt lgkmcnt(6)
    v_mfma_f32_16x16x32_bf16 v[68:71], a[48:51], v[216:219], v[68:71]
    v_mfma_f32_16x16x32_bf16 v[96:99], a[48:51], v[220:223], v[96:99]
    ds_read_b128 a[44:47], v7 offset:33792
    s_waitcnt lgkmcnt(6)
    v_mfma_f32_16x16x32_bf16 v[72:75], a[52:55], v[216:219], v[72:75]
    v_mfma_f32_16x16x32_bf16 v[100:103], a[52:55], v[220:223], v[100:103]
    ds_read_b128 a[48:51], v7 offset:34816
    s_waitcnt lgkmcnt(6)
    v_mfma_f32_16x16x32_bf16 v[68:71], a[56:59], v[224:227], v[68:71]
    v_mfma_f32_16x16x32_bf16 v[96:99], a[56:59], v[228:231], v[96:99]
    ds_read_b128 a[52:55], v7 offset:35840
    s_waitcnt lgkmcnt(6)
    v_mfma_f32_16x16x32_bf16 v[72:75], a[60:63], v[224:227], v[72:75]
    v_mfma_f32_16x16x32_bf16 v[100:103], a[60:63], v[228:231], v[100:103]
    s_waitcnt lgkmcnt(5)
    v_mfma_f32_16x16x32_bf16 v[68:71], a[64:67], v[232:235], v[68:71]
    v_mfma_f32_16x16x32_bf16 v[96:99], a[64:67], v[236:239], v[96:99]
    s_waitcnt lgkmcnt(4)
    v_mfma_f32_16x16x32_bf16 v[72:75], a[68:71], v[232:235], v[72:75]
    v_mfma_f32_16x16x32_bf16 v[100:103], a[68:71], v[236:239], v[100:103]
    s_waitcnt lgkmcnt(3)
    v_mfma_f32_16x16x32_bf16 v[68:71], a[40:43], v[240:243], v[68:71]
    v_mfma_f32_16x16x32_bf16 v[96:99], a[40:43], v[244:247], v[96:99]
    s_waitcnt lgkmcnt(2)
    v_mfma_f32_16x16x32_bf16 v[72:75], a[44:47], v[240:243], v[72:75]
    v_mfma_f32_16x16x32_bf16 v[100:103], a[44:47], v[244:247], v[100:103]
    s_waitcnt lgkmcnt(1)
    v_mfma_f32_16x16x32_bf16 v[68:71], a[48:51], v[248:251], v[68:71]
    v_mfma_f32_16x16x32_bf16 v[96:99], a[48:51], v[252:255], v[96:99]
    s_waitcnt lgkmcnt(0)
    v_mfma_f32_16x16x32_bf16 v[72:75], a[52:55], v[248:251], v[72:75]
    v_mfma_f32_16x16x32_bf16 v[100:103], a[52:55], v[252:255], v[100:103]
    s_waitcnt vmcnt(0)
    v_cmp_ne_u32 vcc, s4, v35
    s_nop 5
    s_cbranch_vccz L_skip_55
    s_mov_b64 exec, vcc
    s_mov_b32 s42, 400000
L_poll_56:
    buffer_load_dwordx4 v[32:35], v41, s[44:47], s88 offen sc1
    s_waitcnt vmcnt(0)
    v_cmp_ne_u32 vcc, s4, v35
    s_nop 1
    s_cbranch_vccz L_polld_57
    s_mov_b64 exec, vcc
    s_sub_u32 s42, s42, 1
    s_cbranch_scc0 L_poll_56
L_polld_57:
    s_mov_b64 exec, -1
L_skip_55:
    v_lshlrev_b32 v116, 16, v32
    v_and_b32 v117, s101, v32
    v_lshlrev_b32 v118, 16, v33
    v_and_b32 v119, s101, v33
    v_lshlrev_b32 v120, 16, v34
    v_and_b32 v121, s101, v34
    v_add_f32_dpp v116, v116, v116 row_ror:8 row_mask:0xf bank_mask:0xf
    v_add_f32_dpp v117, v117, v117 row_ror:8 row_mask:0xf bank_mask:0xf
    v_add_f32_dpp v118, v118, v118 row_ror:8 row_mask:0xf bank_mask:0xf
    v_add_f32_dpp v119, v119, v119 row_ror:8 row_mask:0xf bank_mask:0xf
    v_add_f32_dpp v120, v120, v120 row_ror:8 row_mask:0xf bank_mask:0xf
    v_add_f32_dpp v121, v121, v121 row_ror:8 row_mask:0xf bank_mask:0xf
    v_add_f32_dpp v116, v116, v116 row_ror:4 row_mask:0xf bank_mask:0xf
    v_add_f32_dpp v117, v117, v117 row_ror:4 row_mask:0xf bank_mask:0xf
    v_add_f32_dpp v118, v118, v118 row_ror:4 row_mask:0xf bank_mask:0xf
    v_add_f32_dpp v119, v119, v119 row_ror:4 row_mask:0xf bank_mask:0xf
    v_add_f32_dpp v120, v120, v120 row_ror:4 row_mask:0xf bank_mask:0xf
    v_add_f32_dpp v121, v121, v121 row_ror:4 row_mask:0xf bank_mask:0xf
    v_add_f32_dpp v116, v116, v116 row_ror:2 row_mask:0xf bank_mask:0xf
    v_add_f32_dpp v117, v117, v117 row_ror:2 row_mask:0xf bank_mask:0xf
    v_add_f32_dpp v118, v118, v118 row_ror:2 row_mask:0xf bank_mask:0xf
    v_add_f32_dpp v119, v119, v119 row_ror:2 row_mask:0xf bank_mask:0xf
    v_add_f32_dpp v120, v120, v120 row_ror:2 row_mask:0xf bank_mask:0xf
    v_add_f32_dpp v121, v121, v121 row_ror:2 row_mask:0xf bank_mask:0xf
    v_add_f32_dpp v116, v116, v116 row_ror:1 row_mask:0xf bank_mask:0xf
    v_add_f32_dpp v117, v117, v117 row_ror:1 row_mask:0xf bank_mask:0xf
    v_add_f32_dpp v118, v118, v118 row_ror:1 row_mask:0xf bank_mask:0xf
    v_add_f32_dpp v119, v119, v119 row_ror:1 row_mask:0xf bank_mask:0xf
    v_add_f32_dpp v120, v120, v120 row_ror:1 row_mask:0xf bank_mask:0xf
    v_add_f32_dpp v121, v121, v121 row_ror:1 row_mask:0xf bank_mask:0xf
    v_accvgpr_read_b32 v41, a207
    v_cvt_pk_bf16_f32 v32, v116, v117
    v_cvt_pk_bf16_f32 v33, v118, v119
    v_cvt_pk_bf16_f32 v34, v120, v121
    s_mov_b32 exec_lo, 0x10001
    s_mov_b32 exec_hi, 0x10001
    buffer_store_dwordx4 v[32:35], v41, s[44:47], s89 offen sc1
    s_mov_b64 exec, -1
    v_lshlrev_b32 v153, 7, v2
    buffer_load_dword v152, v153, s[44:47], s15 offen offset:12 sc1
    v_mov_b32 v137, 0
    v_mov_b64 v[138:139], 0
    v_mov_b32 v149, 0
    v_mov_b64 v[150:151], 0
    v_accvgpr_read_b32 v155, a221
    buffer_load_dwordx4 v4, s[44:47], s92 offen offset:3072 sc1 lds
    s_add_u32 s91, s91, 4096
    s_add_u32 s92, s92, 4096
    v_max3_f32 v26, v67, v68, v69
    v_max3_f32 v27, -v67, -v68, -v69
    v_max3_f32 v42, v95, v96, v97
    v_max3_f32 v43, -v95, -v96, -v97
    v_max3_f32 v26, v26, v70, v71
    v_max3_f32 v27, v27, -v70, -v71
    s_mov_b32 m0, s91
    s_nop 0
    buffer_load_dwordx4 v4, s[44:47], s92 offen sc1 lds
    v_max3_f32 v42, v42, v98, v99
    v_max3_f32 v43, v43, -v98, -v99
    v_max3_f32 v26, v26, v72, v73
    v_max3_f32 v27, v27, -v72, -v73
    v_max3_f32 v42, v42, v100, v101
    v_max3_f32 v43, v43, -v100, -v101
    buffer_load_dwordx4 v4, s[44:47], s92 offen offset:1024 sc1 lds
    v_max3_f32 v26, v26, v74, v75
    v_max3_f32 v27, v27, -v74, -v75
    v_max3_f32 v42, v42, v102, v103
    v_max3_f32 v43, v43, -v102, -v103
    v_permlane16_swap_b32 v26, v27
    s_nop 0
    v_permlane16_swap_b32 v42, v43
    buffer_load_dwordx4 v4, s[44:47], s92 offen offset:2048 sc1 lds
    v_max_f32 v26, v26, v27
    v_max_f32 v42, v42, v43
    v_mul_f32 v26, v8, v26
    v_mul_f32 v42, v10, v42
    v_mov_b32 v27, v26
    v_mov_b32 v43, v42
    buffer_load_dwordx4 v4, s[44:47], s92 offen offset:3072 sc1 lds
    s_add_u32 s91, s91, 4096
    s_add_u32 s92, s92, 4096
    v_permlane16_swap_b32 v26, v27
    v_permlane16_swap_b32 v42, v43
    v_pk_fma_f32 v[16:17], v[68:69], v[8:9], v[26:27] op_sel:[0,0,1] op_sel_hi:[1,0,1] neg_lo:[1,0,1] neg_hi:[1,0,1]
    v_pk_fma_f32 v[68:69], v[68:69], v[8:9], v[26:27] op_sel_hi:[1,0,0] neg_lo:[0,0,1] neg_hi:[0,0,1]
    v_pk_fma_f32 v[32:33], v[96:97], v[10:11], v[42:43] op_sel:[0,0,1] op_sel_hi:[1,0,1] neg_lo:[1,0,1] neg_hi:[1,0,1]
    v_pk_fma_f32 v[96:97], v[96:97], v[10:11], v[42:43] op_sel_hi:[1,0,0] neg_lo:[0,0,1] neg_hi:[0,0,1]
    s_mov_b32 m0, s91
    s_nop 0
    buffer_load_dwordx4 v4, s[44:47], s92 offen sc1 lds
    v_pk_fma_f32 v[18:19], v[70:71], v[8:9], v[26:27] op_sel:[0,0,1] op_sel_hi:[1,0,1] neg_lo:[1,0,1] neg_hi:[1,0,1]
    v_pk_fma_f32 v[70:71], v[70:71], v[8:9], v[26:27] op_sel_hi:[1,0,0] neg_lo:[0,0,1] neg_hi:[0,0,1]
    v_pk_fma_f32 v[34:35], v[98:99], v[10:11], v[42:43] op_sel:[0,0,1] op_sel_hi:[1,0,1] neg_lo:[1,0,1] neg_hi:[1,0,1]
    v_pk_fma_f32 v[98:99], v[98:99], v[10:11], v[42:43] op_sel_hi:[1,0,0] neg_lo:[0,0,1] neg_hi:[0,0,1]
    v_pk_fma_f32 v[20:21], v[72:73], v[8:9], v[26:27] op_sel:[0,0,1] op_sel_hi:[1,0,1] neg_lo:[1,0,1] neg_hi:[1,0,1]
    v_pk_fma_f32 v[72:73], v[72:73], v[8:9], v[26:27] op_sel_hi:[1,0,0] neg_lo:[0,0,1] neg_hi:[0,0,1]
    buffer_load_dwordx4 v4, s[44:47], s92 offen offset:1024 sc1 lds
    v_pk_fma_f32 v[36:37], v[100:101], v[10:11], v[42:43] op_sel:[0,0,1] op_sel_hi:[1,0,1] neg_lo:[1,0,1] neg_hi:[1,0,1]
    v_pk_fma_f32 v[100:101], v[100:101], v[10:11], v[42:43] op_sel_hi:[1,0,0] neg_lo:[0,0,1] neg_hi:[0,0,1]
    v_pk_fma_f32 v[22:23], v[74:75], v[8:9], v[26:27] op_sel:[0,0,1] op_sel_hi:[1,0,1] neg_lo:[1,0,1] neg_hi:[1,0,1]
    v_pk_fma_f32 v[74:75], v[74:75], v[8:9], v[26:27] op_sel_hi:[1,0,0] neg_lo:[0,0,1] neg_hi:[0,0,1]
    v_pk_fma_f32 v[38:39], v[102:103], v[10:11], v[42:43] op_sel:[0,0,1] op_sel_hi:[1,0,1] neg_lo:[1,0,1] neg_hi:[1,0,1]
    v_pk_fma_f32 v[102:103], v[102:103], v[10:11], v[42:43] op_sel_hi:[1,0,0] neg_lo:[0,0,1] neg_hi:[0,0,1]
    buffer_load_dwordx4 v4, s[44:47], s92 offen offset:2048 sc1 lds
    v_fma_f32 v24, v67, v8, -v26
    v_fma_f32 v25, -v67, v8, -v27
    v_fma_f32 v40, v95, v10, -v42
    v_fma_f32 v41, -v95, v10, -v43
    v_exp_f32 v68, v68
    v_exp_f32 v16, v16
    buffer_load_dwordx4 v4, s[44:47], s92 offen offset:3072 sc1 lds
    s_add_u32 s91, s91, 4096
    s_add_u32 s92, s92, 4096
    v_exp_f32 v69, v69
    v_exp_f32 v17, v17
    v_exp_f32 v70, v70
    v_exp_f32 v18, v18
    v_exp_f32 v71, v71
    v_exp_f32 v19, v19
    s_mov_b32 m0, s91
    s_nop 0
    buffer_load_dwordx4 v4, s[44:47], s92 offen sc1 lds
    v_exp_f32 v72, v72
    v_exp_f32 v20, v20
    v_exp_f32 v73, v73
    v_exp_f32 v21, v21
    v_exp_f32 v74, v74
    v_exp_f32 v22, v22
    v_exp_f32 v75, v75
    v_exp_f32 v23, v23
    v_exp_f32 v24, v24
    v_exp_f32 v25, v25
    v_exp_f32 v96, v96
    v_exp_f32 v32, v32
    v_exp_f32 v97, v97
    v_exp_f32 v33, v33
    v_exp_f32 v98, v98
    v_exp_f32 v34, v34
    v_exp_f32 v99, v99
    v_exp_f32 v35, v35
    v_exp_f32 v100, v100
    v_exp_f32 v36, v36
    v_exp_f32 v101, v101
    v_exp_f32 v37, v37
    v_exp_f32 v102, v102
    v_exp_f32 v38, v38
    v_exp_f32 v103, v103
    v_exp_f32 v39, v39
    v_exp_f32 v40, v40
    v_exp_f32 v41, v41
    v_pk_add_f32 v[28:29], v[68:69], v[70:71]
    v_pk_add_f32 v[30:31], v[16:17], v[18:19]
    v_pk_add_f32 v[44:45], v[96:97], v[98:99]
    v_pk_add_f32 v[46:47], v[32:33], v[34:35]
    v_pk_add_f32 v[28:29], v[28:29], v[72:73]
    v_pk_add_f32 v[30:31], v[30:31], v[20:21]
    v_pk_add_f32 v[44:45], v[44:45], v[100:101]
    v_pk_add_f32 v[46:47], v[46:47], v[36:37]
    v_pk_add_f32 v[28:29], v[28:29], v[74:75]
    v_pk_add_f32 v[30:31], v[30:31], v[22:23]
    v_pk_add_f32 v[44:45], v[44:45], v[102:103]
    v_pk_add_f32 v[46:47], v[46:47], v[38:39]
    v_add_f32 v26, v28, v29
    v_add_f32 v27, v30, v31
    v_add_f32 v42, v44, v45
    v_add_f32 v43, v46, v47
    v_pk_add_f32 v[26:27], v[26:27], v[24:25]
    v_pk_add_f32 v[42:43], v[42:43], v[40:41]
    s_nop 0
    v_permlane16_swap_b32 v26, v27
    v_permlane16_swap_b32 v42, v43
    v_add_f32 v26, v26, v27
    v_add_f32 v42, v42, v43
    v_rcp_f32 v26, v26
    v_rcp_f32 v42, v42
    v_mov_b32 v27, v26
    v_mov_b32 v43, v42
    s_nop 0
    v_permlane16_swap_b32 v26, v27
    v_permlane16_swap_b32 v42, v43
    v_pk_mul_f32 v[68:69], v[68:69], v[26:27] op_sel_hi:[1,0]
    v_pk_mul_f32 v[16:17], v[16:17], v[26:27] op_sel:[0,1] op_sel_hi:[1,1]
    v_pk_mul_f32 v[96:97], v[96:97], v[42:43] op_sel_hi:[1,0]
    v_pk_mul_f32 v[32:33], v[32:33], v[42:43] op_sel:[0,1] op_sel_hi:[1,1]
    v_pk_mul_f32 v[70:71], v[70:71], v[26:27] op_sel_hi:[1,0]
    v_pk_mul_f32 v[18:19], v[18:19], v[26:27] op_sel:[0,1] op_sel_hi:[1,1]
    v_pk_mul_f32 v[98:99], v[98:99], v[42:43] op_sel_hi:[1,0]
    v_pk_mul_f32 v[34:35], v[34:35], v[42:43] op_sel:[0,1] op_sel_hi:[1,1]
    v_pk_mul_f32 v[72:73], v[72:73], v[26:27] op_sel_hi:[1,0]
    v_pk_mul_f32 v[20:21], v[20:21], v[26:27] op_sel:[0,1] op_sel_hi:[1,1]
    v_pk_mul_f32 v[100:101], v[100:101], v[42:43] op_sel_hi:[1,0]
    v_pk_mul_f32 v[36:37], v[36:37], v[42:43] op_sel:[0,1] op_sel_hi:[1,1]
    v_pk_mul_f32 v[74:75], v[74:75], v[26:27] op_sel_hi:[1,0]
    v_pk_mul_f32 v[22:23], v[22:23], v[26:27] op_sel:[0,1] op_sel_hi:[1,1]
    v_pk_mul_f32 v[102:103], v[102:103], v[42:43] op_sel_hi:[1,0]
    v_pk_mul_f32 v[38:39], v[38:39], v[42:43] op_sel:[0,1] op_sel_hi:[1,1]
    v_pk_mul_f32 v[24:25], v[24:25], v[26:27]
    v_pk_mul_f32 v[40:41], v[40:41], v[42:43]
    v_cvt_pk_bf16_f32 v128, v24, v68
    v_cvt_pk_bf16_f32 v129, v69, v70
    v_cvt_pk_bf16_f32 v130, v71, v72
    v_cvt_pk_bf16_f32 v131, v73, v74
    v_cvt_pk_bf16_f32 v132, v75, v25
    v_cvt_pk_bf16_f32 v133, v16, v17
    v_cvt_pk_bf16_f32 v134, v18, v19
    v_cvt_pk_bf16_f32 v135, v20, v21
    v_cvt_pk_bf16_f32 v136, v22, v23
    v_cvt_pk_bf16_f32 v140, v40, v96
    v_cvt_pk_bf16_f32 v141, v97, v98
    v_cvt_pk_bf16_f32 v142, v99, v100
    v_cvt_pk_bf16_f32 v143, v101, v102
    v_cvt_pk_bf16_f32 v144, v103, v41
    v_cvt_pk_bf16_f32 v145, v32, v33
    v_cvt_pk_bf16_f32 v146, v34, v35
    v_cvt_pk_bf16_f32 v147, v36, v37
    v_cvt_pk_bf16_f32 v148, v38, v39
    s_waitcnt vmcnt(11)
    buffer_load_dwordx4 v[156:159], v155, s[44:47], s89 offen sc1
    v_accvgpr_read_b32 v42, a208
    v_accvgpr_read_b32 v43, a223
    v_mov_b32 v44, 0
    v_accvgpr_read_b32 v16, a209
    v_accvgpr_read_b32 v17, a210
    v_accvgpr_read_b32 v18, a211
    v_accvgpr_read_b32 v20, a212
    v_accvgpr_read_b32 v21, a213
    s_mov_b64 exec, s[74:75]
    ds_write2_b32 v43, v44, v44 offset0:0 offset1:1
    ds_write_b32 v43, v44 offset:8
    s_mov_b64 exec, -1
    s_waitcnt vmcnt(11)
    v_cmp_ne_u32 vcc, s4, v152
    s_nop 1
    s_cbranch_vccz L_skip_58
    s_mov_b64 exec, vcc
    s_mov_b32 s42, 400000
L_poll_59:
    buffer_load_dword v152, v153, s[44:47], s15 offen offset:12 sc1
    s_waitcnt vmcnt(0)
    v_cmp_ne_u32 vcc, s4, v152
    s_nop 1
    s_cbranch_vccz L_polld_60
    s_mov_b64 exec, vcc
    s_sub_u32 s42, s42, 1
    s_cbranch_scc0 L_poll_59
L_polld_60:
    s_mov_b64 exec, -1
L_skip_58:
    s_mov_b64 exec, s[76:77]
    s_waitcnt vmcnt(0)
    v_cmp_ne_u32 vcc, s4, v159
    s_mov_b64 exec, -1
    s_nop 0
    s_cbranch_vccz L_skip_61
    s_mov_b64 exec, vcc
    s_mov_b32 s42, 400000
L_poll_62:
    buffer_load_dwordx4 v[156:159], v155, s[44:47], s89 offen sc1
    s_waitcnt vmcnt(0)
    v_cmp_ne_u32 vcc, s4, v159
    s_nop 1
    s_cbranch_vccz L_polld_63
    s_mov_b64 exec, vcc
    s_sub_u32 s42, s42, 1
    s_cbranch_scc0 L_poll_62
L_polld_63:
    s_mov_b64 exec, -1
L_skip_61:
    s_mov_b64 exec, s[78:79]
    ds_write2_b32 v42, v156, v157 offset0:0 offset1:1
    ds_write_b32 v42, v158 offset:8
    s_mov_b64 exec, -1
    s_waitcnt lgkmcnt(0)
    s_barrier
    ds_read_b128 a[72:75], v16 offset:0
    ds_read_b128 a[76:79], v16 offset:16
    ds_read_b128 a[80:83], v16 offset:32
    ds_read_b128 a[84:87], v17 offset:0
    ds_read_b128 a[88:91], v17 offset:16
    ds_read_b128 a[92:95], v17 offset:32
    ds_read_b128 a[96:99], v18 offset:0
    ds_read_b128 a[100:103], v18 offset:16
    ds_read_b128 a[104:107], v18 offset:32
    s_waitcnt lgkmcnt(2)
    v_mfma_f32_16x16x32_bf16 v[56:59], a[96:99], v[128:131], 0
    v_mfma_f32_16x16x32_bf16 v[68:71], a[96:99], v[140:143], 0
    s_waitcnt lgkmcnt(1)
    v_mfma_f32_16x16x32_bf16 v[56:59], a[100:103], v[132:135], v[56:59]
    v_mfma_f32_16x16x32_bf16 v[68:71], a[100:103], v[144:147], v[68:71]
    s_waitcnt lgkmcnt(0)
    v_mfma_f32_16x16x32_bf16 v[56:59], a[104:107], v[136:139], v[56:59]
    v_mfma_f32_16x16x32_bf16 v[68:71], a[104:107], v[148:151], v[68:71]
    v_mfma_f32_16x16x32_bf16 v[48:51], a[72:75], v[128:131], 0
    v_mfma_f32_16x16x32_bf16 v[60:63], a[72:75], v[140:143], 0
    v_mfma_f32_16x16x32_bf16 v[48:51], a[76:79], v[132:135], v[48:51]
    v_mfma_f32_16x16x32_bf16 v[60:63], a[76:79], v[144:147], v[60:63]
    v_mfma_f32_16x16x32_bf16 v[48:51], a[80:83], v[136:139], v[48:51]
    v_mfma_f32_16x16x32_bf16 v[60:63], a[80:83], v[148:151], v[60:63]
    v_mfma_f32_16x16x32_bf16 v[52:55], a[84:87], v[128:131], 0
    v_mfma_f32_16x16x32_bf16 v[64:67], a[84:87], v[140:143], 0
    v_mfma_f32_16x16x32_bf16 v[52:55], a[88:91], v[132:135], v[52:55]
    v_mfma_f32_16x16x32_bf16 v[64:67], a[88:91], v[144:147], v[64:67]
    v_mfma_f32_16x16x32_bf16 v[52:55], a[92:95], v[136:139], v[52:55]
    v_mfma_f32_16x16x32_bf16 v[64:67], a[92:95], v[148:151], v[64:67]
    v_add_f32 v22, 0x358637bd, v56
    v_add_f32 v24, 0x358637bd, v68
    v_rcp_f32 v22, v22
    v_rcp_f32 v24, v24
    v_mul_f32 v57, v22, v57
    v_mul_f32 v58, v22, v58
    v_cvt_pk_bf16_f32 v36, v57, v58
    v_mul_f32 v69, v24, v69
    v_mul_f32 v70, v24, v70
    v_cvt_pk_bf16_f32 v37, v69, v70
    v_pk_mul_f32 v[48:49], v[48:49], v[22:23] op_sel_hi:[1,0]
    v_pk_mul_f32 v[50:51], v[50:51], v[22:23] op_sel_hi:[1,0]
    v_pk_mul_f32 v[52:53], v[52:53], v[22:23] op_sel_hi:[1,0]
    v_pk_mul_f32 v[54:55], v[54:55], v[22:23] op_sel_hi:[1,0]
    v_cvt_pk_bf16_f32 v28, v48, v49
    v_cvt_pk_bf16_f32 v29, v50, v51
    v_cvt_pk_bf16_f32 v30, v52, v53
    v_cvt_pk_bf16_f32 v31, v54, v55
    v_pk_mul_f32 v[60:61], v[60:61], v[24:25] op_sel_hi:[1,0]
    v_pk_mul_f32 v[62:63], v[62:63], v[24:25] op_sel_hi:[1,0]
    v_pk_mul_f32 v[64:65], v[64:65], v[24:25] op_sel_hi:[1,0]
    v_pk_mul_f32 v[66:67], v[66:67], v[24:25] op_sel_hi:[1,0]
    v_cvt_pk_bf16_f32 v32, v60, v61
    v_cvt_pk_bf16_f32 v33, v62, v63
    v_cvt_pk_bf16_f32 v34, v64, v65
    v_cvt_pk_bf16_f32 v35, v66, v67
    v_permlane32_swap_b32 v36, v37
    s_cmp_eq_u32 s13, 0
    s_nop 0
    s_cbranch_scc1 L_far_64
    buffer_store_dwordx4 v[28:31], v20, s[44:47], s87 offen offset:0
    buffer_store_dwordx4 v[32:35], v20, s[44:47], s87 offen offset:128
    s_mov_b32 exec_lo, 0xffff
    s_mov_b32 exec_hi, 0xffff
    buffer_store_dwordx2 v[36:37], v21, s[44:47], s87 offen
    s_mov_b64 exec, -1
    s_branch L_join_65
L_far_64:
    buffer_store_dwordx4 v[28:31], v20, s[44:47], s87 offen offset:0 sc1
    buffer_store_dwordx4 v[32:35], v20, s[44:47], s87 offen offset:128 sc1
    s_mov_b32 exec_lo, 0xffff
    s_mov_b32 exec_hi, 0xffff
    buffer_store_dwordx2 v[36:37], v21, s[44:47], s87 offen sc1
    s_mov_b64 exec, -1
L_join_65:
    s_lshl_b32 s5, s72, 4
    s_add_u32 s5, s5, s69
    s_lshl_b32 s5, s5, 7
    s_add_u32 s5, s5, s90
    v_accvgpr_read_b32 v68, a240
    v_lshlrev_b32 v48, 16, v68
    v_and_b32 v49, s101, v68
    v_accvgpr_read_b32 v69, a241
    v_lshlrev_b32 v50, 16, v69
    v_and_b32 v51, s101, v69
    v_accvgpr_read_b32 v68, a242
    v_lshlrev_b32 v52, 16, v68
    v_and_b32 v53, s101, v68
    v_accvgpr_read_b32 v69, a243
    v_lshlrev_b32 v54, 16, v69
    v_and_b32 v55, s101, v69
    v_accvgpr_read_b32 v68, a244
    v_lshlrev_b32 v56, 16, v68
    v_and_b32 v57, s101, v68
    v_accvgpr_read_b32 v69, a245
    v_lshlrev_b32 v58, 16, v69
    v_and_b32 v59, s101, v69
    v_accvgpr_read_b32 v68, a246
    v_lshlrev_b32 v60, 16, v68
    v_and_b32 v61, s101, v68
    v_accvgpr_read_b32 v69, a247
    v_lshlrev_b32 v62, 16, v69
    v_and_b32 v63, s101, v69
    v_accvgpr_read_b32 v68, a248
    v_lshlrev_b32 v64, 16, v68
    v_and_b32 v65, s101, v68
    v_accvgpr_read_b32 v69, a249
    v_lshlrev_b32 v66, 16, v69
    v_and_b32 v67, s101, v69
    s_waitcnt vmcnt(0)
    s_mov_b32 exec_lo, 0xff
    s_mov_b32 exec_hi, 0x0
    s_cmp_eq_u32 s13, 0
    s_cbranch_scc1 L_far_66
    buffer_store_dwordx4 v[2:5], v4, s[44:47], s5 offen
    s_nop 1
    s_branch L_join_67
L_far_66:
    buffer_store_dwordx4 v[2:5], v4, s[44:47], s5 offen sc1
    s_nop 1
L_join_67:
    s_mov_b64 exec, -1
    v_add_u32 v6, 41472, v4
    v_accvgpr_read_b32 v7, a219
    v_add_u32 v8, 41472, v7
    v_lshlrev_b32 v9, 8, v3
    v_lshl_add_u32 v9, v2, 3, v9
    v_accvgpr_read_b32 v16, a214
    s_mov_b32 s7, 13418496
    s_mov_b32 s8, 13422592
    s_lshl_b32 s9, s70, 2
    s_add_u32 s9, s9, s3
    s_mul_i32 s9, s9, 18432
    s_add_u32 s9, s9, s87
    ds_read_b128 a[0:3], v4 offset:0
    ds_read_b128 a[4:7], v4 offset:1024
    ds_read_b128 a[8:11], v4 offset:2048
    ds_read_b128 a[12:15], v4 offset:3072
    ds_read_b128 a[16:19], v7 offset:0
    ds_read_b128 a[20:23], v4 offset:4608
    ds_read_b128 a[24:27], v4 offset:5632
    ds_read_b128 a[28:31], v4 offset:6656
    ds_read_b128 a[32:35], v4 offset:7680
    ds_read_b128 a[36:39], v7 offset:4608
    v_lshlrev_b32 v17, 7, v2
    s_lshl_b32 s5, s73, 11
    s_add_u32 s5, s5, s90
    s_waitcnt vmcnt(0)
    s_mov_b32 exec_lo, 0xffff
    s_mov_b32 exec_hi, 0x0
    s_mov_b32 s42, 400000
L_poll_68:
    buffer_load_dword v18, v17, s[44:47], s5 offen offset:12 sc1
    s_waitcnt vmcnt(0)
    v_cmp_ne_u32 vcc, s4, v18
    s_nop 1
    s_cbranch_vccz L_polld_69
    s_mov_b64 exec, vcc
    s_sub_u32 s42, s42, 1
    s_cbranch_scc0 L_poll_68
L_polld_69:
    s_mov_b64 exec, -1
    buffer_load_dwordx4 v[112:115], v4, s[44:47], s9 offen sc1
    buffer_load_dwordx4 v[116:119], v4, s[44:47], s9 offen offset:1024 sc1
    buffer_load_dwordx4 v[120:123], v4, s[44:47], s9 offen offset:2048 sc1
    buffer_load_dwordx4 v[124:127], v4, s[44:47], s9 offen offset:3072 sc1
    s_add_u32 s9, s9, 4096
    buffer_load_dwordx4 v[128:131], v4, s[44:47], s9 offen sc1
    buffer_load_dwordx4 v[132:135], v4, s[44:47], s9 offen offset:1024 sc1
    buffer_load_dwordx4 v[136:139], v4, s[44:47], s9 offen offset:2048 sc1
    buffer_load_dwordx4 v[140:143], v4, s[44:47], s9 offen offset:3072 sc1
    s_waitcnt vmcnt(7) lgkmcnt(9)
    v_mfma_f32_16x16x32_bf16 v[48:51], a[0:3], v[112:115], v[48:51]
    ds_read_b128 a[40:43], v4 offset:9216
    s_add_u32 s9, s9, 4096
    buffer_load_dwordx4 v[144:147], v4, s[44:47], s9 offen sc1
    s_waitcnt lgkmcnt(9)
    v_mfma_f32_16x16x32_bf16 v[52:55], a[4:7], v[112:115], v[52:55]
    ds_read_b128 a[44:47], v4 offset:10240
    s_waitcnt lgkmcnt(9)
    v_mfma_f32_16x16x32_bf16 v[56:59], a[8:11], v[112:115], v[56:59]
    ds_read_b128 a[48:51], v4 offset:11264
    s_waitcnt lgkmcnt(9)
    v_mfma_f32_16x16x32_bf16 v[60:63], a[12:15], v[112:115], v[60:63]
    ds_read_b128 a[52:55], v4 offset:12288
    s_waitcnt lgkmcnt(9)
    v_mfma_f32_16x16x32_bf16 v[64:67], a[16:19], v[112:115], v[64:67]
    ds_read_b128 a[56:59], v7 offset:9216
    s_waitcnt vmcnt(7) lgkmcnt(9)
    v_mfma_f32_16x16x32_bf16 v[48:51], a[20:23], v[116:119], v[48:51]
    ds_read_b128 a[0:3], v4 offset:13824
    buffer_load_dwordx4 v[148:151], v4, s[44:47], s9 offen offset:1024 sc1
    s_waitcnt lgkmcnt(9)
    v_mfma_f32_16x16x32_bf16 v[52:55], a[24:27], v[116:119], v[52:55]
    ds_read_b128 a[4:7], v4 offset:14848
    s_waitcnt lgkmcnt(9)
    v_mfma_f32_16x16x32_bf16 v[56:59], a[28:31], v[116:119], v[56:59]
    ds_read_b128 a[8:11], v4 offset:15872
    s_waitcnt lgkmcnt(9)
    v_mfma_f32_16x16x32_bf16 v[60:63], a[32:35], v[116:119], v[60:63]
    ds_read_b128 a[12:15], v4 offset:16896
    s_waitcnt lgkmcnt(9)
    v_mfma_f32_16x16x32_bf16 v[64:67], a[36:39], v[116:119], v[64:67]
    ds_read_b128 a[16:19], v7 offset:13824
    s_waitcnt vmcnt(7) lgkmcnt(9)
    v_mfma_f32_16x16x32_bf16 v[48:51], a[40:43], v[120:123], v[48:51]
    ds_read_b128 a[20:23], v4 offset:18432
    buffer_load_dwordx4 v[152:155], v4, s[44:47], s9 offen offset:2048 sc1
    s_waitcnt lgkmcnt(9)
    v_mfma_f32_16x16x32_bf16 v[52:55], a[44:47], v[120:123], v[52:55]
    ds_read_b128 a[24:27], v4 offset:19456
    s_waitcnt lgkmcnt(9)
    v_mfma_f32_16x16x32_bf16 v[56:59], a[48:51], v[120:123], v[56:59]
    ds_read_b128 a[28:31], v4 offset:20480
    s_waitcnt lgkmcnt(9)
    v_mfma_f32_16x16x32_bf16 v[60:63], a[52:55], v[120:123], v[60:63]
    ds_read_b128 a[32:35], v4 offset:21504
    s_waitcnt lgkmcnt(9)
    v_mfma_f32_16x16x32_bf16 v[64:67], a[56:59], v[120:123], v[64:67]
    ds_read_b128 a[36:39], v7 offset:18432
    s_waitcnt vmcnt(7) lgkmcnt(9)
    v_mfma_f32_16x16x32_bf16 v[48:51], a[0:3], v[124:127], v[48:51]
    ds_read_b128 a[40:43], v4 offset:23040
    buffer_load_dwordx4 v[156:159], v4, s[44:47], s9 offen offset:3072 sc1
    s_waitcnt lgkmcnt(9)
    v_mfma_f32_16x16x32_bf16 v[52:55], a[4:7], v[124:127], v[52:55]
    ds_read_b128 a[44:47], v4 offset:24064
    s_waitcnt lgkmcnt(9)
    v_mfma_f32_16x16x32_bf16 v[56:59], a[8:11], v[124:127], v[56:59]
    ds_read_b128 a[48:51], v4 offset:25088
    s_waitcnt lgkmcnt(9)
    v_mfma_f32_16x16x32_bf16 v[60:63], a[12:15], v[124:127], v[60:63]
    ds_read_b128 a[52:55], v4 offset:26112
    s_waitcnt lgkmcnt(9)
    v_mfma_f32_16x16x32_bf16 v[64:67], a[16:19], v[124:127], v[64:67]
    ds_read_b128 a[56:59], v7 offset:23040
    s_waitcnt vmcnt(7) lgkmcnt(9)
    v_mfma_f32_16x16x32_bf16 v[48:51], a[20:23], v[128:131], v[48:51]
    ds_read_b128 a[0:3], v4 offset:27648
    s_add_u32 s9, s9, 4096
    buffer_load_dwordx4 v[160:163], v4, s[44:47], s9 offen sc1
    s_waitcnt lgkmcnt(9)
    v_mfma_f32_16x16x32_bf16 v[52:55], a[24:27], v[128:131], v[52:55]
    ds_read_b128 a[4:7], v4 offset:28672
    s_waitcnt lgkmcnt(9)
    v_mfma_f32_16x16x32_bf16 v[56:59], a[28:31], v[128:131], v[56:59]
    ds_read_b128 a[8:11], v4 offset:29696
    s_waitcnt lgkmcnt(9)
    v_mfma_f32_16x16x32_bf16 v[60:63], a[32:35], v[128:131], v[60:63]
    ds_read_b128 a[12:15], v4 offset:30720
    s_waitcnt lgkmcnt(9)
    v_mfma_f32_16x16x32_bf16 v[64:67], a[36:39], v[128:131], v[64:67]
    ds_read_b128 a[16:19], v7 offset:27648
    s_waitcnt vmcnt(7) lgkmcnt(9)
    v_mfma_f32_16x16x32_bf16 v[48:51], a[40:43], v[132:135], v[48:51]
    ds_read_b128 a[20:23], v4 offset:32256
    buffer_load_dwordx4 v[164:167], v4, s[44:47], s9 offen offset:1024 sc1
    s_waitcnt lgkmcnt(9)
    v_mfma_f32_16x16x32_bf16 v[52:55], a[44:47], v[132:135], v[52:55]
    ds_read_b128 a[24:27], v4 offset:33280
    s_waitcnt lgkmcnt(9)
    v_mfma_f32_16x16x32_bf16 v[56:59], a[48:51], v[132:135], v[56:59]
    ds_read_b128 a[28:31], v4 offset:34304
    s_waitcnt lgkmcnt(9)
    v_mfma_f32_16x16x32_bf16 v[60:63], a[52:55], v[132:135], v[60:63]
    ds_read_b128 a[32:35], v4 offset:35328
    s_waitcnt lgkmcnt(9)
    v_mfma_f32_16x16x32_bf16 v[64:67], a[56:59], v[132:135], v[64:67]
    ds_read_b128 a[36:39], v7 offset:32256
    s_waitcnt vmcnt(7) lgkmcnt(9)
    v_mfma_f32_16x16x32_bf16 v[48:51], a[0:3], v[136:139], v[48:51]
    ds_read_b128 a[40:43], v4 offset:36864
    buffer_load_dwordx4 v[168:171], v4, s[44:47], s9 offen offset:2048 sc1
    s_waitcnt lgkmcnt(9)
    v_mfma_f32_16x16x32_bf16 v[52:55], a[4:7], v[136:139], v[52:55]
    ds_read_b128 a[44:47], v4 offset:37888
    s_waitcnt lgkmcnt(9)
    v_mfma_f32_16x16x32_bf16 v[56:59], a[8:11], v[136:139], v[56:59]
    ds_read_b128 a[48:51], v4 offset:38912
    s_waitcnt lgkmcnt(9)
    v_mfma_f32_16x16x32_bf16 v[60:63], a[12:15], v[136:139], v[60:63]
    ds_read_b128 a[52:55], v4 offset:39936
    s_waitcnt lgkmcnt(9)
    v_mfma_f32_16x16x32_bf16 v[64:67], a[16:19], v[136:139], v[64:67]
    ds_read_b128 a[56:59], v7 offset:36864
    s_waitcnt vmcnt(7) lgkmcnt(9)
    v_mfma_f32_16x16x32_bf16 v[48:51], a[20:23], v[140:143], v[48:51]
    ds_read_b128 a[0:3], v6 offset:0
    buffer_load_dwordx4 v[172:175], v4, s[44:47], s9 offen offset:3072 sc1
    s_waitcnt lgkmcnt(9)
    v_mfma_f32_16x16x32_bf16 v[52:55], a[24:27], v[140:143], v[52:55]
    ds_read_b128 a[4:7], v6 offset:1024
    s_waitcnt lgkmcnt(9)
    v_mfma_f32_16x16x32_bf16 v[56:59], a[28:31], v[140:143], v[56:59]
    ds_read_b128 a[8:11], v6 offset:2048
    s_waitcnt lgkmcnt(9)
    v_mfma_f32_16x16x32_bf16 v[60:63], a[32:35], v[140:143], v[60:63]
    ds_read_b128 a[12:15], v6 offset:3072
    s_waitcnt lgkmcnt(9)
    v_mfma_f32_16x16x32_bf16 v[64:67], a[36:39], v[140:143], v[64:67]
    ds_read_b128 a[16:19], v8 offset:0
    s_waitcnt vmcnt(7) lgkmcnt(9)
    v_mfma_f32_16x16x32_bf16 v[48:51], a[40:43], v[144:147], v[48:51]
    ds_read_b128 a[20:23], v6 offset:4608
    s_add_u32 s9, s9, 4096
    buffer_load_dwordx2 v[176:177], v9, s[44:47], s9 offen offset:0 sc1
    buffer_load_dwordx2 v[178:179], v9, s[44:47], s9 offen offset:128 sc1
    s_waitcnt lgkmcnt(9)
    v_mfma_f32_16x16x32_bf16 v[52:55], a[44:47], v[144:147], v[52:55]
    ds_read_b128 a[24:27], v6 offset:5632
    s_waitcnt lgkmcnt(9)
    v_mfma_f32_16x16x32_bf16 v[56:59], a[48:51], v[144:147], v[56:59]
    ds_read_b128 a[28:31], v6 offset:6656
    s_waitcnt lgkmcnt(9)
    v_mfma_f32_16x16x32_bf16 v[60:63], a[52:55], v[144:147], v[60:63]
    ds_read_b128 a[32:35], v6 offset:7680
    s_waitcnt lgkmcnt(9)
    v_mfma_f32_16x16x32_bf16 v[64:67], a[56:59], v[144:147], v[64:67]
    ds_read_b128 a[36:39], v8 offset:4608
    s_waitcnt vmcnt(8) lgkmcnt(9)
    v_mfma_f32_16x16x32_bf16 v[48:51], a[0:3], v[148:151], v[48:51]
    ds_read_b128 a[40:43], v6 offset:9216
    buffer_load_dwordx2 v[180:181], v9, s[44:47], s9 offen offset:1024 sc1
    buffer_load_dwordx2 v[182:183], v9, s[44:47], s9 offen offset:1152 sc1
    s_waitcnt lgkmcnt(9)
    v_mfma_f32_16x16x32_bf16 v[52:55], a[4:7], v[148:151], v[52:55]
    ds_read_b128 a[44:47], v6 offset:10240
    s_waitcnt lgkmcnt(9)
    v_mfma_f32_16x16x32_bf16 v[56:59], a[8:11], v[148:151], v[56:59]
    ds_read_b128 a[48:51], v6 offset:11264
    s_waitcnt lgkmcnt(9)
    v_mfma_f32_16x16x32_bf16 v[60:63], a[12:15], v[148:151], v[60:63]
    ds_read_b128 a[52:55], v6 offset:12288
    s_waitcnt lgkmcnt(9)
    v_mfma_f32_16x16x32_bf16 v[64:67], a[16:19], v[148:151], v[64:67]
    ds_read_b128 a[56:59], v8 offset:9216
    s_waitcnt vmcnt(9) lgkmcnt(9)
    v_mfma_f32_16x16x32_bf16 v[48:51], a[20:23], v[152:155], v[48:51]
    ds_read_b128 a[0:3], v6 offset:13824
    s_waitcnt lgkmcnt(9)
    v_mfma_f32_16x16x32_bf16 v[52:55], a[24:27], v[152:155], v[52:55]
    ds_read_b128 a[4:7], v6 offset:14848
    s_waitcnt lgkmcnt(9)
    v_mfma_f32_16x16x32_bf16 v[56:59], a[28:31], v[152:155], v[56:59]
    ds_read_b128 a[8:11], v6 offset:15872
    s_waitcnt lgkmcnt(9)
    v_mfma_f32_16x16x32_bf16 v[60:63], a[32:35], v[152:155], v[60:63]
    ds_read_b128 a[12:15], v6 offset:16896
    s_waitcnt lgkmcnt(9)
    v_mfma_f32_16x16x32_bf16 v[64:67], a[36:39], v[152:155], v[64:67]
    ds_read_b128 a[16:19], v8 offset:13824
    s_waitcnt vmcnt(8) lgkmcnt(9)
    v_mfma_f32_16x16x32_bf16 v[48:51], a[40:43], v[156:159], v[48:51]
    ds_read_b128 a[20:23], v6 offset:18432
    s_waitcnt lgkmcnt(9)
    v_mfma_f32_16x16x32_bf16 v[52:55], a[44:47], v[156:159], v[52:55]
    ds_read_b128 a[24:27], v6 offset:19456
    s_waitcnt lgkmcnt(9)
    v_mfma_f32_16x16x32_bf16 v[56:59], a[48:51], v[156:159], v[56:59]
    ds_read_b128 a[28:31], v6 offset:20480
    s_waitcnt lgkmcnt(9)
    v_mfma_f32_16x16x32_bf16 v[60:63], a[52:55], v[156:159], v[60:63]
    ds_read_b128 a[32:35], v6 offset:21504
    s_waitcnt lgkmcnt(9)
    v_mfma_f32_16x16x32_bf16 v[64:67], a[56:59], v[156:159], v[64:67]
    ds_read_b128 a[36:39], v8 offset:18432
    s_waitcnt vmcnt(7) lgkmcnt(9)
    v_mfma_f32_16x16x32_bf16 v[48:51], a[0:3], v[160:163], v[48:51]
    ds_read_b128 a[40:43], v6 offset:23040
    buffer_load_dwordx2 v[78:79], v16, s[44:47], s7 offen offset:0 sc1
    s_waitcnt lgkmcnt(9)
    v_mfma_f32_16x16x32_bf16 v[52:55], a[4:7], v[160:163], v[52:55]
    ds_read_b128 a[44:47], v6 offset:24064
    s_waitcnt lgkmcnt(9)
    v_mfma_f32_16x16x32_bf16 v[56:59], a[8:11], v[160:163], v[56:59]
    ds_read_b128 a[48:51], v6 offset:25088
    s_waitcnt lgkmcnt(9)
    v_mfma_f32_16x16x32_bf16 v[60:63], a[12:15], v[160:163], v[60:63]
    ds_read_b128 a[52:55], v6 offset:26112
    s_waitcnt lgkmcnt(9)
    v_mfma_f32_16x16x32_bf16 v[64:67], a[16:19], v[160:163], v[64:67]
    ds_read_b128 a[56:59], v8 offset:23040
    s_waitcnt vmcnt(7) lgkmcnt(9)
    v_mfma_f32_16x16x32_bf16 v[48:51], a[20:23], v[164:167], v[48:51]
    ds_read_b128 a[0:3], v6 offset:27648
    buffer_load_dwordx2 v[80:81], v16, s[44:47], s7 offen offset:1024 sc1
    s_waitcnt lgkmcnt(9)
    v_mfma_f32_16x16x32_bf16 v[52:55], a[24:27], v[164:167], v[52:55]
    ds_read_b128 a[4:7], v6 offset:28672
    s_waitcnt lgkmcnt(9)
    v_mfma_f32_16x16x32_bf16 v[56:59], a[28:31], v[164:167], v[56:59]
    ds_read_b128 a[8:11], v6 offset:29696
    s_waitcnt lgkmcnt(9)
    v_mfma_f32_16x16x32_bf16 v[60:63], a[32:35], v[164:167], v[60:63]
    ds_read_b128 a[12:15], v6 offset:30720
    s_waitcnt lgkmcnt(9)
    v_mfma_f32_16x16x32_bf16 v[64:67], a[36:39], v[164:167], v[64:67]
    ds_read_b128 a[16:19], v8 offset:27648
    s_waitcnt vmcnt(7) lgkmcnt(9)
    v_mfma_f32_16x16x32_bf16 v[48:51], a[40:43], v[168:171], v[48:51]
    ds_read_b128 a[20:23], v6 offset:32256
    buffer_load_dwordx2 v[82:83], v16, s[44:47], s7 offen offset:2048 sc1
    s_waitcnt lgkmcnt(9)
    v_mfma_f32_16x16x32_bf16 v[52:55], a[44:47], v[168:171], v[52:55]
    ds_read_b128 a[24:27], v6 offset:33280
    s_waitcnt lgkmcnt(9)
    v_mfma_f32_16x16x32_bf16 v[56:59], a[48:51], v[168:171], v[56:59]
    ds_read_b128 a[28:31], v6 offset:34304
    s_waitcnt lgkmcnt(9)
    v_mfma_f32_16x16x32_bf16 v[60:63], a[52:55], v[168:171], v[60:63]
    ds_read_b128 a[32:35], v6 offset:35328
    s_waitcnt lgkmcnt(9)
    v_mfma_f32_16x16x32_bf16 v[64:67], a[56:59], v[168:171], v[64:67]
    ds_read_b128 a[36:39], v8 offset:32256
    s_waitcnt vmcnt(7) lgkmcnt(9)
    v_mfma_f32_16x16x32_bf16 v[48:51], a[0:3], v[172:175], v[48:51]
    ds_read_b128 a[40:43], v6 offset:36864
    buffer_load_dwordx2 v[84:85], v16, s[44:47], s7 offen offset:3072 sc1
    s_waitcnt lgkmcnt(9)
    v_mfma_f32_16x16x32_bf16 v[52:55], a[4:7], v[172:175], v[52:55]
    ds_read_b128 a[44:47], v6 offset:37888
    s_waitcnt lgkmcnt(9)
    v_mfma_f32_16x16x32_bf16 v[56:59], a[8:11], v[172:175], v[56:59]
    ds_read_b128 a[48:51], v6 offset:38912
    s_waitcnt lgkmcnt(9)
    v_mfma_f32_16x16x32_bf16 v[60:63], a[12:15], v[172:175], v[60:63]
    ds_read_b128 a[52:55], v6 offset:39936
    s_waitcnt lgkmcnt(9)
    v_mfma_f32_16x16x32_bf16 v[64:67], a[16:19], v[172:175], v[64:67]
    ds_read_b128 a[56:59], v8 offset:36864
    s_waitcnt vmcnt(6) lgkmcnt(9)
    v_mfma_f32_16x16x32_bf16 v[48:51], a[20:23], v[176:179], v[48:51]
    buffer_load_dwordx2 v[86:87], v16, s[44:47], s8 offen offset:0 sc1
    s_waitcnt lgkmcnt(8)
    v_mfma_f32_16x16x32_bf16 v[52:55], a[24:27], v[176:179], v[52:55]
    s_waitcnt lgkmcnt(7)
    v_mfma_f32_16x16x32_bf16 v[56:59], a[28:31], v[176:179], v[56:59]
    s_waitcnt lgkmcnt(6)
    v_mfma_f32_16x16x32_bf16 v[60:63], a[32:35], v[176:179], v[60:63]
    s_waitcnt lgkmcnt(5)
    v_mfma_f32_16x16x32_bf16 v[64:67], a[36:39], v[176:179], v[64:67]
    s_waitcnt vmcnt(5) lgkmcnt(4)
    v_mfma_f32_16x16x32_bf16 v[48:51], a[40:43], v[180:183], v[48:51]
    s_waitcnt lgkmcnt(3)
    v_mfma_f32_16x16x32_bf16 v[52:55], a[44:47], v[180:183], v[52:55]
    s_waitcnt lgkmcnt(2)
    v_mfma_f32_16x16x32_bf16 v[56:59], a[48:51], v[180:183], v[56:59]
    s_waitcnt lgkmcnt(1)
    v_mfma_f32_16x16x32_bf16 v[60:63], a[52:55], v[180:183], v[60:63]
    s_waitcnt lgkmcnt(0)
    v_mfma_f32_16x16x32_bf16 v[64:67], a[56:59], v[180:183], v[64:67]
    s_cmp_lg_u32 s43, 0
    s_nop 6
    s_cbranch_scc1 L_last
    s_mov_b32 exec_lo, 0x0
    s_mov_b32 exec_hi, 0xffffffff
    v_mov_b64 v[64:65], 0
    v_mov_b64 v[66:67], 0
    s_mov_b64 exec, -1
    v_pk_add_f32 v[8:9], v[48:49], v[50:51]
    v_pk_mul_f32 v[10:11], v[48:49], v[48:49]
    v_pk_fma_f32 v[10:11], v[50:51], v[50:51], v[10:11]
    v_pk_add_f32 v[8:9], v[8:9], v[52:53]
    v_pk_fma_f32 v[10:11], v[52:53], v[52:53], v[10:11]
    v_pk_add_f32 v[8:9], v[8:9], v[54:55]
    v_pk_fma_f32 v[10:11], v[54:55], v[54:55], v[10:11]
    v_pk_add_f32 v[8:9], v[8:9], v[56:57]
    v_pk_fma_f32 v[10:11], v[56:57], v[56:57], v[10:11]
    v_pk_add_f32 v[8:9], v[8:9], v[58:59]
    v_pk_fma_f32 v[10:11], v[58:59], v[58:59], v[10:11]
    v_pk_add_f32 v[8:9], v[8:9], v[60:61]
    v_pk_fma_f32 v[10:11], v[60:61], v[60:61], v[10:11]
    v_pk_add_f32 v[8:9], v[8:9], v[62:63]
    v_pk_fma_f32 v[10:11], v[62:63], v[62:63], v[10:11]
    v_pk_add_f32 v[8:9], v[8:9], v[64:65]
    v_pk_fma_f32 v[10:11], v[64:65], v[64:65], v[10:11]
    v_pk_add_f32 v[8:9], v[8:9], v[66:67]
    v_pk_fma_f32 v[10:11], v[66:67], v[66:67], v[10:11]
    v_add_f32 v12, v8, v9
    v_add_f32 v13, v10, v11
    v_accvgpr_read_b32 v16, a215
    v_mov_b32 v15, v5
    v_mov_b32 v14, 0
    v_permlane16_swap_b32 v12, v13
    v_add_f32 v12, v12, v13
    v_mov_b32 v13, v12
    s_nop 1
    v_permlane32_swap_b32 v12, v13
    v_add_f32 v12, v12, v13
    v_mov_b32 v13, v12
    s_nop 1
    v_permlane16_swap_b32 v12, v13
    s_mov_b32 exec_lo, 0xffff
    s_mov_b32 exec_hi, 0x0
    s_cmp_eq_u32 s13, 0
    s_cbranch_scc1 L_far_70
    buffer_store_dwordx4 v[12:15], v16, s[44:47], 0 offen
    s_nop 1
    s_branch L_join_71
L_far_70:
    buffer_store_dwordx4 v[12:15], v16, s[44:47], 0 offen sc1
    s_nop 1
L_join_71:
    s_mov_b64 exec, -1
    s_mul_i32 s91, s3, 23552
    s_add_u32 s92, s97, s91
    s_barrier
    s_mov_b32 m0, s91
    s_nop 0
    buffer_load_dwordx4 v4, s[44:47], s92 offen sc1 lds
    buffer_load_dwordx4 v4, s[44:47], s92 offen offset:1024 sc1 lds
    buffer_load_dwordx4 v4, s[44:47], s92 offen offset:2048 sc1 lds
    buffer_load_dwordx4 v4, s[44:47], s92 offen offset:3072 sc1 lds
    s_add_u32 s91, s91, 4096
    s_add_u32 s92, s92, 4096
    s_mov_b32 m0, s91
    s_nop 0
    buffer_load_dwordx4 v4, s[44:47], s92 offen sc1 lds
    s_waitcnt vmcnt(10)
    v_lshlrev_b32 v132, 16, v78
    v_and_b32 v133, s101, v78
    v_lshlrev_b32 v134, 16, v79
    v_and_b32 v135, s101, v79
    s_waitcnt vmcnt(9)
    v_lshlrev_b32 v136, 16, v80
    v_and_b32 v137, s101, v80
    v_lshlrev_b32 v138, 16, v81
    v_and_b32 v139, s101, v81
    s_waitcnt vmcnt(8)
    v_lshlrev_b32 v140, 16, v82
    v_and_b32 v141, s101, v82
    v_lshlrev_b32 v142, 16, v83
    v_and_b32 v143, s101, v83
    s_waitcnt vmcnt(7)
    v_lshlrev_b32 v144, 16, v84
    v_and_b32 v145, s101, v84
    v_lshlrev_b32 v146, 16, v85
    v_and_b32 v147, s101, v85
    s_waitcnt vmcnt(6)
    v_lshlrev_b32 v148, 16, v86
    v_and_b32 v149, s101, v86
    v_lshlrev_b32 v150, 16, v87
    v_and_b32 v151, s101, v87
    v_accvgpr_read_b32 v16, a216
    s_movk_i32 s5, 4096
    s_waitcnt vmcnt(5)
    buffer_load_dwordx4 v[20:23], v16, s[44:47], 0 offen sc1
    buffer_load_dwordx4 v[24:27], v16, s[44:47], s5 offen sc1
    buffer_load_dwordx4 v4, s[44:47], s92 offen offset:1024 sc1 lds
    buffer_load_dwordx4 v4, s[44:47], s92 offen offset:2048 sc1 lds
    buffer_load_dwordx4 v4, s[44:47], s92 offen offset:3072 sc1 lds
    s_add_u32 s91, s91, 4096
    s_add_u32 s92, s92, 4096
    s_mov_b32 m0, s91
    s_nop 0
    buffer_load_dwordx4 v4, s[44:47], s92 offen sc1 lds
    buffer_load_dwordx4 v4, s[44:47], s92 offen offset:1024 sc1 lds
    buffer_load_dwordx4 v4, s[44:47], s92 offen offset:2048 sc1 lds
    s_waitcnt vmcnt(7)
    v_cmp_ne_u32 vcc, s4, v23
    s_waitcnt vmcnt(6)
    v_cmp_ne_u32 s[82:83], s4, v27
    s_nop 0
    s_or_b64 vcc, vcc, s[82:83]
    s_nop 2
    s_cbranch_vccz L_skip_72
    s_mov_b64 exec, vcc
    s_mov_b32 s42, 400000
L_poll_73:
    buffer_load_dwordx4 v[20:23], v16, s[44:47], 0 offen sc1
    buffer_load_dwordx4 v[24:27], v16, s[44:47], s5 offen sc1
    s_waitcnt vmcnt(0)
    v_cmp_ne_u32 vcc, s4, v23
    v_cmp_ne_u32 s[82:83], s4, v27
    s_nop 0
    s_or_b64 vcc, vcc, s[82:83]
    s_nop 2
    s_cbranch_vccz L_polld_74
    s_mov_b64 exec, vcc
    s_sub_u32 s42, s42, 1
    s_cbranch_scc0 L_poll_73
L_polld_74:
    s_mov_b64 exec, -1
L_skip_72:
    v_pk_add_f32 v[20:21], v[20:21], v[24:25]
    s_nop 1
    v_permlane16_swap_b32 v20, v21
    v_add_f32 v20, v20, v21
    v_mov_b32 v21, v20
    s_nop 1
    v_permlane32_swap_b32 v20, v21
    v_add_f32 v20, v20, v21
    v_mov_b32 v21, v20
    s_nop 1
    v_permlane16_swap_b32 v20, v21
    v_mul_f32 v20, 0x3ae38e39, v20
    v_mul_f32 v21, 0x3ae38e39, v21
    v_fma_f32 v21, -v20, v20, v21
    v_max_f32 v21, 0, v21
    v_add_f32 v21, 0x3727c5ac, v21
    v_rsq_f32 v8, v21
    s_nop 0
    v_mul_f32 v10, v20, v8
    v_sub_f32 v10, 0, v10
    v_pk_fma_f32 v[112:113], v[48:49], v[8:9], v[10:11] op_sel_hi:[1,0,0]
    v_pk_fma_f32 v[114:115], v[50:51], v[8:9], v[10:11] op_sel_hi:[1,0,0]
    v_pk_fma_f32 v[116:117], v[52:53], v[8:9], v[10:11] op_sel_hi:[1,0,0]
    v_pk_fma_f32 v[118:119], v[54:55], v[8:9], v[10:11] op_sel_hi:[1,0,0]
    v_pk_fma_f32 v[120:121], v[56:57], v[8:9], v[10:11] op_sel_hi:[1,0,0]
    v_pk_fma_f32 v[122:123], v[58:59], v[8:9], v[10:11] op_sel_hi:[1,0,0]
    v_pk_fma_f32 v[124:125], v[60:61], v[8:9], v[10:11] op_sel_hi:[1,0,0]
    v_pk_fma_f32 v[126:127], v[62:63], v[8:9], v[10:11] op_sel_hi:[1,0,0]
    v_pk_fma_f32 v[128:129], v[64:65], v[8:9], v[10:11] op_sel_hi:[1,0,0]
    v_pk_fma_f32 v[130:131], v[66:67], v[8:9], v[10:11] op_sel_hi:[1,0,0]
    v_pk_fma_f32 v[112:113], v[112:113], v[132:133], v[48:49]
    v_pk_fma_f32 v[114:115], v[114:115], v[134:135], v[50:51]
    v_pk_fma_f32 v[116:117], v[116:117], v[136:137], v[52:53]
    v_pk_fma_f32 v[118:119], v[118:119], v[138:139], v[54:55]
    v_pk_fma_f32 v[120:121], v[120:121], v[140:141], v[56:57]
    v_pk_fma_f32 v[122:123], v[122:123], v[142:143], v[58:59]
    v_pk_fma_f32 v[124:125], v[124:125], v[144:145], v[60:61]
    v_pk_fma_f32 v[126:127], v[126:127], v[146:147], v[62:63]
    v_pk_fma_f32 v[128:129], v[128:129], v[148:149], v[64:65]
    v_pk_fma_f32 v[130:131], v[130:131], v[150:151], v[66:67]
    v_cvt_pk_bf16_f32 v28, v112, v113
    v_cvt_pk_bf16_f32 v29, v114, v115
    v_cvt_pk_bf16_f32 v30, v116, v117
    v_cvt_pk_bf16_f32 v31, v118, v119
    v_cvt_pk_bf16_f32 v32, v120, v121
    v_cvt_pk_bf16_f32 v33, v122, v123
    v_cvt_pk_bf16_f32 v34, v124, v125
    v_cvt_pk_bf16_f32 v35, v126, v127
    v_cvt_pk_bf16_f32 v36, v128, v129
    v_cvt_pk_bf16_f32 v37, v130, v131
    v_accvgpr_read_b32 v16, a217
    v_mov_b64 v[8:9], 0
    s_mov_b32 exec_lo, 0xffffffff
    s_mov_b32 exec_hi, 0x0
    v_dot2c_f32_bf16 v8, v36, v36
    v_dot2c_f32_bf16 v9, v37, v37
    s_mov_b64 exec, -1
    v_dot2c_f32_bf16 v8, v28, v28
    v_dot2c_f32_bf16 v9, v29, v29
    v_dot2c_f32_bf16 v8, v30, v30
    v_dot2c_f32_bf16 v9, v31, v31
    v_dot2c_f32_bf16 v8, v32, v32
    v_dot2c_f32_bf16 v9, v33, v33
    v_dot2c_f32_bf16 v8, v34, v34
    v_dot2c_f32_bf16 v9, v35, v35
    s_nop 2
    v_add_f32 v8, v8, v9
    v_accvgpr_read_b32 v17, a229
    v_mov_b32 v9, v8
    s_nop 1
    v_permlane16_swap_b32 v8, v9
    v_add_f32 v8, v8, v9
    v_mov_b32 v9, v8
    s_nop 1
    v_permlane32_swap_b32 v8, v9
    v_add_f32 v8, v8, v9
    v_mov_b64 v[18:19], v[28:29]
    v_mov_b32_dpp v28, v30 row_ror:8 row_mask:0xf bank_mask:0xc
    v_mov_b32_dpp v29, v31 row_ror:8 row_mask:0xf bank_mask:0xc
    v_mov_b32_dpp v30, v18 row_ror:8 row_mask:0xf bank_mask:0x3
    v_mov_b32_dpp v31, v19 row_ror:8 row_mask:0xf bank_mask:0x3
    v_mov_b64 v[18:19], v[32:33]
    v_mov_b32_dpp v32, v34 row_ror:8 row_mask:0xf bank_mask:0xc
    v_mov_b32_dpp v33, v35 row_ror:8 row_mask:0xf bank_mask:0xc
    v_mov_b32_dpp v34, v18 row_ror:8 row_mask:0xf bank_mask:0x3
    v_mov_b32_dpp v35, v19 row_ror:8 row_mask:0xf bank_mask:0x3
    v_mov_b64 v[38:39], 0
    s_nop 1
    v_mov_b32_dpp v38, v36 row_ror:8 row_mask:0xf bank_mask:0x3
    v_mov_b32_dpp v39, v37 row_ror:8 row_mask:0xf bank_mask:0x3
    s_cmp_eq_u32 s13, 0
    s_nop 0
    s_cbranch_scc1 L_far_75
    buffer_store_dwordx4 v[28:31], v16, s[44:47], s87 offen offset:0
    buffer_store_dwordx4 v[32:35], v16, s[44:47], s87 offen offset:1024
    s_mov_b32 exec_lo, 0xff00ff
    s_mov_b32 exec_hi, 0x0
    buffer_store_dwordx4 v[36:39], v16, s[44:47], s87 offen offset:2048
    s_mov_b32 exec_lo, 0xffff
    s_mov_b32 exec_hi, 0x0
    buffer_store_dword v8, v17, s[44:47], 0 offen
    s_mov_b64 exec, -1
    s_branch L_join_76
L_far_75:
    buffer_store_dwordx4 v[28:31], v16, s[44:47], s87 offen offset:0 sc1
    buffer_store_dwordx4 v[32:35], v16, s[44:47], s87 offen offset:1024 sc1
    s_mov_b32 exec_lo, 0xff00ff
    s_mov_b32 exec_hi, 0x0
    buffer_store_dwordx4 v[36:39], v16, s[44:47], s87 offen offset:2048 sc1
    s_mov_b32 exec_lo, 0xffff
    s_mov_b32 exec_hi, 0x0
    buffer_store_dword v8, v17, s[44:47], 0 offen sc1
    s_mov_b64 exec, -1
L_join_76:
    buffer_load_dwordx4 v4, s[44:47], s92 offen offset:3072 sc1 lds
    s_add_u32 s91, s91, 4096
    s_add_u32 s92, s92, 4096
    s_mov_b32 m0, s91
    s_nop 0
    buffer_load_dwordx4 v4, s[44:47], s92 offen sc1 lds
    buffer_load_dwordx4 v4, s[44:47], s92 offen offset:1024 sc1 lds
    buffer_load_dwordx4 v4, s[44:47], s92 offen offset:2048 sc1 lds
    s_lshl_b32 s5, s73, 4
    s_lshl_b32 s6, s71, 1
    s_add_u32 s5, s5, s6
    s_and_b32 s6, s3, 1
    s_add_u32 s5, s5, s6
    s_lshl_b32 s5, s5, 7
    s_add_u32 s5, s5, 552960
    s_waitcnt vmcnt(4)
    s_mov_b32 exec_lo, 0xff
    s_mov_b32 exec_hi, 0x0
    s_cmp_eq_u32 s13, 0
    s_cbranch_scc1 L_far_77
    buffer_store_dwordx4 v[2:5], v4, s[44:47], s5 offen
    s_nop 1
    s_branch L_join_78
L_far_77:
    buffer_store_dwordx4 v[2:5], v4, s[44:47], s5 offen sc1
    s_nop 1
L_join_78:
    s_mov_b64 exec, -1
    buffer_load_dwordx4 v4, s[44:47], s92 offen offset:3072 sc1 lds
    s_add_u32 s91, s91, 4096
    s_add_u32 s92, s92, 4096
    s_mov_b32 m0, s91
    s_nop 0
    buffer_load_dwordx4 v4, s[44:47], s92 offen sc1 lds
    buffer_load_dwordx4 v4, s[44:47], s92 offen offset:1024 sc1 lds
    buffer_load_dwordx4 v4, s[44:47], s92 offen offset:2048 sc1 lds
    s_mov_b32 s43, 1
    s_mov_b64 s[80:81], -1
    s_mul_i32 s86, s72, 36864
    s_add_u32 s86, s86, 11059200
    s_add_u32 s15, s15, 32768
    s_add_u32 s88, s88, 1048576
    s_add_u32 s89, s89, 65536
    s_add_u32 s90, s90, 131072
    v_lshlrev_b32 v17, 7, v2
    s_lshl_b32 s5, s72, 11
    s_add_u32 s5, s5, 552960
    s_waitcnt vmcnt(4)
    buffer_load_dword v18, v17, s[44:47], s5 offen offset:12 sc1
    buffer_load_dwordx4 v4, s[44:47], s92 offen offset:3072 sc1 lds
    s_add_u32 s91, s91, 4096
    s_add_u32 s92, s92, 4096
    s_mov_b32 m0, s91
    s_nop 0
    buffer_load_dwordx4 v4, s[44:47], s92 offen sc1 lds
    buffer_load_dwordx4 v4, s[44:47], s92 offen offset:1024 sc1 lds
    buffer_load_dwordx4 v4, s[44:47], s92 offen offset:2048 sc1 lds
    s_waitcnt vmcnt(4)
    v_cmp_ne_u32 vcc, s4, v18
    s_nop 1
    s_cbranch_vccz L_skip_79
    s_mov_b64 exec, vcc
    s_mov_b32 s42, 400000
L_poll_80:
    buffer_load_dword v18, v17, s[44:47], s5 offen offset:12 sc1
    s_waitcnt vmcnt(0)
    v_cmp_ne_u32 vcc, s4, v18
    s_nop 1
    s_cbranch_vccz L_polld_81
    s_mov_b64 exec, vcc
    s_sub_u32 s42, s42, 1
    s_cbranch_scc0 L_poll_80
L_polld_81:
    s_mov_b64 exec, -1
L_skip_79:
    s_branch L_layer
L_last:
    v_accvgpr_read_b32 v16, a218
    v_cvt_pk_bf16_f32 v28, v48, v49
    v_cvt_pk_bf16_f32 v29, v50, v51
    v_cvt_pk_bf16_f32 v30, v52, v53
    v_cvt_pk_bf16_f32 v31, v54, v55
    v_cvt_pk_bf16_f32 v32, v56, v57
    v_cvt_pk_bf16_f32 v33, v58, v59
    v_cvt_pk_bf16_f32 v34, v60, v61
    v_cvt_pk_bf16_f32 v35, v62, v63
    v_cvt_pk_bf16_f32 v36, v64, v65
    v_cvt_pk_bf16_f32 v37, v66, v67
    v_mov_b64 v[38:39], 0
    v_permlane16_swap_b32 v28, v30
    v_permlane16_swap_b32 v29, v31
    buffer_store_dwordx4 v[28:31], v16, s[64:67], 0 offen offset:0
    v_permlane16_swap_b32 v32, v34
    v_permlane16_swap_b32 v33, v35
    buffer_store_dwordx4 v[32:35], v16, s[64:67], 0 offen offset:64
    v_permlane16_swap_b32 v36, v38
    v_permlane16_swap_b32 v37, v39
    s_mov_b32 exec_lo, 0xffff
    s_mov_b32 exec_hi, 0x0
    buffer_store_dwordx4 v[36:39], v16, s[64:67], 0 offen offset:128
    s_mov_b64 exec, -1
    s_nop 0
L_fin:
    s_or_b32 s5, s2, s3
    s_cmp_lg_u32 s5, 0
    s_cbranch_scc1 L_skip_82
    s_mov_b32 s5, 0
    s_mov_b32 exec_lo, 0xff
    s_mov_b32 exec_hi, 0x0
    buffer_store_dwordx4 v[2:5], v4, s[44:47], s5 offen sc1
    s_mov_b64 exec, -1
    s_nop 0
L_skip_82:
L_end:
    s_endpgm
.section .rodata,"a"
.p2align 6
.amdhsa_kernel interleave_layers__ssm_conv_h3__linear_kernel_hedgehog__prompt_kernel
  .amdhsa_next_free_vgpr 512
  .amdhsa_next_free_sgpr 102
  .amdhsa_accum_offset 256
  .amdhsa_group_segment_fixed_size 0
  .amdhsa_kernarg_size 104
  .amdhsa_user_sgpr_count 2
  .amdhsa_user_sgpr_kernarg_segment_ptr 1
  .amdhsa_system_sgpr_workgroup_id_x 1
  .amdhsa_float_denorm_mode_32 3
.end_amdhsa_kernel
```
